```python
import torch

def _softmax(x, axis=-1):
    return torch.softmax(x, dim=axis)
def _gelu(x):
    return torch.nn.functional.gelu(x, approximate="tanh")
def _silu(x):
    return torch.nn.functional.silu(x)
def _sigmoid(x):
    return torch.sigmoid(x)
def _layernorm(x, axis=-1, eps=1e-5):
    m = x.mean(dim=axis, keepdim=True)
    v = x.var(dim=axis, keepdim=True, unbiased=False)
    return (x - m) / torch.sqrt(v + eps)
def _scatter_add(tgt, idx, src, axis=0):
    return tgt.clone().index_add_(axis, idx, src)
def _segment_sum(src, seg, n):
    out = torch.zeros((n,) + src.shape[1:], dtype=src.dtype)
    return out.index_add_(0, seg, src)
def _pad(x, pw):
    flat = tuple(v for pair in reversed(pw) for v in pair)
    return torch.nn.functional.pad(x, flat)

kernel_name = 'parallel_sum__mha_block_cached__dense_activation_gelu__decode'

def setup_inputs():

    _w = (lambda a: (lambda t: t.to(torch.bfloat16) if t.is_floating_point() else t)(torch.as_tensor(a)))
    def _A_setup():
        B, Sq, D = 1, 1, 576
        H, Sk, Dh = 32, 32768, 128
        return {
            "x": _w((lambda *s: torch.randn(*s, dtype=torch.bfloat16) * 0.05)(B, Sq, D)),
            "k_cache": _w((lambda *s: torch.randn(*s, dtype=torch.bfloat16) * 3.2)(B, H, Sk, Dh)),
            "v_cache": _w((lambda *s: torch.randn(*s, dtype=torch.bfloat16) * 0.8)(B, H, Sk, Dh)),
            "wq": _w((lambda *s: torch.randn(*s, dtype=torch.bfloat16) * 3.2)(D, H * Dh) * (D ** -0.5)),
            "wo": _w((lambda *s: torch.randn(*s, dtype=torch.bfloat16) * 0.8)(H * Dh, D) * ((H * Dh) ** -0.5)),
        }
    _A_in = _A_setup()

    def _B_setup():
        B, S, D, F = 1, 1, 576, 4608
        return {
            "x": _w((lambda *s: torch.randn(*s, dtype=torch.bfloat16) * 0.05)(B, S, D)),
            "w1": _w((lambda *s: torch.randn(*s, dtype=torch.bfloat16) * 3.2)(D, F) * (D ** -0.5)),
            "b1": _w((lambda *s: torch.randn(*s, dtype=torch.bfloat16) * 3.2)(F) * 0.01),
            "w2": _w((lambda *s: torch.randn(*s, dtype=torch.bfloat16) * 0.4)(F, D) * (F ** -0.5)),
            "b2": _w((lambda *s: torch.randn(*s, dtype=torch.bfloat16) * 0.4)(D) * 0.01),
        }
    _B_in = _B_setup()

    return {
        "A_x": _A_in["x"],
        "A_k_cache": _A_in["k_cache"],
        "A_v_cache": _A_in["v_cache"],
        "A_wq": _A_in["wq"],
        "A_wo": _A_in["wo"],
        "B_x": _B_in["x"],
        "B_w1": _B_in["w1"],
        "B_b1": _B_in["b1"],
        "B_w2": _B_in["w2"],
        "B_b2": _B_in["b2"],
    }

def reference(A_x, A_k_cache, A_v_cache, A_wq, A_wo, B_x, B_w1, B_b1, B_w2, B_b2):
    def _A_ref(x, k_cache, v_cache, wq, wo):
        B, Sq, D = x.shape
        H, Dh = 32, 128
        q = (lambda x, *d: x.permute(*d))((x @ wq).reshape(B, Sq, H, Dh), 0, 2, 1, 3)
        scores = torch.einsum("bhqd,bhkd->bhqk", q, k_cache) * (Dh ** -0.5)
        p = _softmax(scores, axis=-1)
        o = torch.einsum("bhqk,bhkd->bhqd", p, v_cache)
        return (lambda x, *d: x.permute(*d))(o, 0, 2, 1, 3).reshape(B, Sq, H * Dh) @ wo

    def _B_ref(x, w1, b1, w2, b2):
        h = torch.einsum("bsd,df->bsf", x, w1) + b1
        h = _gelu(h)
        return torch.einsum("bsf,fd->bsd", h, w2) + b2

    x = A_x
    xn = _layernorm(x, axis=-1)
    return x + _A_ref(xn, A_k_cache, A_v_cache, A_wq, A_wo) + _B_ref(xn, B_w1, B_b1, B_w2, B_b2)
```

```asm
; @launch grid=(256,1,1) block=(512,1,1) lds=163456
.amdgcn_target "amdgcn-amd-amdhsa--gfx950"
.text
.globl parallel_sum__mha_block_cached__dense_activation_gelu__decode_kernel
.p2align 8
.type parallel_sum__mha_block_cached__dense_activation_gelu__decode_kernel,@function
parallel_sum__mha_block_cached__dense_activation_gelu__decode_kernel:
    s_cmp_ge_u32 s2, 256
    s_cbranch_scc1 L_end
    s_load_dwordx16 s[36:51], s[0:1], 0
    s_load_dwordx8 s[52:59], s[0:1], 64
    s_load_dwordx2 s[60:61], s[0:1], 96
    v_lshrrev_b32 v4, 6, v0
    v_and_b32 v1, 63, v0
    v_readfirstlane_b32 s3, v4
    s_nop 1
    s_cmp_lg_u32 s3, 5
    s_cbranch_scc1 L_nowarm
    s_getpc_b64 s[4:5]
L_pc:
    v_lshlrev_b32 v5, 4, v1
    v_mov_b32 v7, s5
    v_add_co_u32 v6, vcc, s4, v5
    s_mov_b32 s6, (L_code_end-L_pc+4095)>>12
    s_nop 0
    v_addc_co_u32 v7, vcc, 0, v7, vcc
L_warm:
    global_load_dwordx4 v[12:15], v[6:7], off offset:0
    global_load_dwordx4 v[12:15], v[6:7], off offset:1024
    global_load_dwordx4 v[12:15], v[6:7], off offset:2048
    global_load_dwordx4 v[12:15], v[6:7], off offset:3072
    v_add_co_u32 v6, vcc, 0x1000, v6
    s_sub_u32 s6, s6, 1
    s_nop 0
    v_addc_co_u32 v7, vcc, 0, v7, vcc
    s_cmp_lg_u32 s6, 0
    s_cbranch_scc1 L_warm
    s_waitcnt vmcnt(0)
L_nowarm:
    v_and_b32 v2, 15, v1
    v_lshrrev_b32 v3, 4, v1
    s_and_b32 s28, s2, 7
    s_lshr_b32 s29, s2, 3
    s_lshl_b32 s20, s28, 2
    s_lshr_b32 s30, s29, 3
    s_add_u32 s20, s20, s30
    s_and_b32 s21, s29, 7
    s_add_u32 s30, s30, 4
    s_cmp_eq_u32 s21, 7
    s_cselect_b32 s31, s30, s21
    s_cmp_eq_u32 s21, s30
    s_cselect_b32 s21, 7, s31
    s_mov_b32 s24, 0x3fb8aa3b
    s_mov_b32 s26, 0x3db504f3
    s_cmp_eq_u32 s21, 7
    s_cselect_b32 s22, 154880, 0
    s_cmp_ge_u32 s3, 2
    s_cbranch_scc1 L_other
L_stream:
    v_bfe_u32 v28, v1, 3, 1
    v_lshl_add_u32 v28, v28, 3, v3
    v_lshlrev_b32 v4, 8, v28
    v_and_b32 v28, 7, v1
    v_lshlrev_b32 v44, 4, v28
    v_add_u32 v4, v4, v44
    v_add_u32 v5, 128, v4
    v_add_u32 v6, 1024, v4
    v_add_u32 v7, 1152, v4
    s_lshl_b32 s27, s20, 23
    s_lshl_b32 s17, s3, 12
    s_add_u32 s27, s27, s17
    s_lshl_b32 s17, s21, 20
    s_add_u32 s14, s27, s17
    s_mul_i32 s17, s21, 40960
    s_add_u32 s84, s27, s17
    s_add_u32 s84, s84, 8101888
    s_add_u32 s85, s84, 40960
    s_mov_b32 s23, 133
    s_mov_b32 s19, 4800
    s_mov_b32 s17, 0x100000
    s_cmp_eq_u32 s21, 7
    s_cselect_b32 s23, 93, s23
    s_cselect_b32 s19, 3520, s19
    s_cselect_b32 s17, 761856, s17
    s_cselect_b32 s85, 0, s85
    s_add_u32 s81, s14, s17
    s_mov_b32 s17, 0
    s_bitcmp1_b32 s20, 0
    s_cselect_b32 s80, 262144, 0
    s_add_u32 s17, s17, s80
    s_bitcmp1_b32 s20, 4
    s_cselect_b32 s80, 32768, 0
    s_add_u32 s17, s17, s80
    s_bitcmp1_b32 s21, 0
    s_cselect_b32 s80, 524288, 0
    s_add_u32 s17, s17, s80
    s_bitcmp1_b32 s21, 2
    s_cselect_b32 s80, 65536, 0
    s_add_u32 s17, s17, s80
    s_sub_u32 s80, s81, s14
    s_cmp_lt_u32 s17, s80
    s_cselect_b32 s17, s17, 0
    s_add_u32 s80, s14, s17
    s_mov_b32 s16, s80
    s_mov_b32 s27, s81
    s_mov_b32 s86, 1
    s_mov_b32 s15, s23
    s_mov_b32 s88, 0
    s_mov_b32 s77, 60
    s_mov_b32 s76, 2
    s_mov_b32 s78, 0
    s_cmp_eq_u32 s21, 7
    s_cselect_b32 s77, 18, s77
    s_cselect_b32 s76, 4, s76
    s_waitcnt lgkmcnt(0)
    s_mov_b32 s8, s38
    s_mov_b32 s9, s39
    s_mov_b32 s10, 0x10000000
    s_mov_b32 s11, 0x20000
    buffer_load_dwordx4 v[52:55], v4, s[8:11], s16 offen nt
    buffer_load_dwordx4 v[56:59], v5, s[8:11], s16 offen nt
    s_barrier
    buffer_load_dwordx4 v[60:63], v6, s[8:11], s16 offen nt
    buffer_load_dwordx4 v[64:67], v7, s[8:11], s16 offen nt
    s_add_u32 s16, s16, 0x2000
    buffer_load_dwordx4 v[68:71], v4, s[8:11], s16 offen nt
    buffer_load_dwordx4 v[72:75], v5, s[8:11], s16 offen nt
    buffer_load_dwordx4 v[76:79], v6, s[8:11], s16 offen nt
    buffer_load_dwordx4 v[80:83], v7, s[8:11], s16 offen nt
    s_add_u32 s16, s16, 0x2000
    buffer_load_dwordx4 v[84:87], v4, s[8:11], s16 offen nt
    buffer_load_dwordx4 v[88:91], v5, s[8:11], s16 offen nt
    buffer_load_dwordx4 v[92:95], v6, s[8:11], s16 offen nt
    v_and_b32 v28, 1, v2
    v_cmp_eq_u32 vcc, 0, v28
    v_mov_b32 v29, 0xffff0000
    v_mov_b32 v30, 0xffff
    v_cndmask_b32 v28, v29, v30, vcc
    v_lshrrev_b32 v29, 1, v2
    v_cmp_eq_u32 vcc, 0, v29
    s_nop 1
    v_cndmask_b32 v8, 0, v28, vcc
    v_cmp_eq_u32 vcc, 1, v29
    s_nop 1
    v_cndmask_b32 v9, 0, v28, vcc
    v_cmp_eq_u32 vcc, 2, v29
    s_nop 1
    v_cndmask_b32 v10, 0, v28, vcc
    v_cmp_eq_u32 vcc, 3, v29
    s_nop 1
    v_cndmask_b32 v11, 0, v28, vcc
    v_mov_b32 v12, 0xff7fffff
    v_mov_b32 v13, 0
    v_mov_b32 v16, 0
    v_mov_b32 v17, 0
    v_mov_b32 v18, 0
    v_mov_b32 v19, 0
    s_mul_i32 s17, s3, 576
    s_add_u32 s17, s17, 256
    s_add_u32 s17, s17, s22
    v_add_u32 v44, s22, v44
    v_lshlrev_b32 v14, 5, v2
    v_lshl_add_u32 v14, v3, 4, v14
    v_add_u32 v14, s17, v14
    v_mov_b32 v15, s17
    s_mul_i32 s17, s3, s19
    s_add_u32 s17, s17, 1536
    s_add_u32 s17, s17, s22
    v_lshrrev_b32 v40, 2, v1
    v_lshl_add_u32 v40, v40, 1, s17
    v_mov_b32 v41, v40
    s_waitcnt vmcnt(10)
    buffer_load_dwordx4 v[96:99], v7, s[8:11], s16 offen nt
    s_waitcnt vmcnt(10)
    s_add_u32 s16, s16, 0x2000
    buffer_load_dwordx4 v[100:103], v4, s[8:11], s16 offen nt
    s_waitcnt vmcnt(10)
    buffer_load_dwordx4 v[104:107], v5, s[8:11], s16 offen nt
    s_waitcnt vmcnt(10)
    buffer_load_dwordx4 v[108:111], v6, s[8:11], s16 offen nt
    s_waitcnt vmcnt(10)
    buffer_load_dwordx4 v[112:115], v7, s[8:11], s16 offen nt
    s_waitcnt vmcnt(10)
    s_add_u32 s16, s16, 0x2000
    buffer_load_dwordx4 v[116:119], v4, s[8:11], s16 offen nt
    s_waitcnt vmcnt(10)
    buffer_load_dwordx4 v[120:123], v5, s[8:11], s16 offen nt
    s_waitcnt vmcnt(10)
    buffer_load_dwordx4 v[124:127], v6, s[8:11], s16 offen nt
    s_waitcnt vmcnt(10)
    buffer_load_dwordx4 v[128:131], v7, s[8:11], s16 offen nt
    s_waitcnt vmcnt(10)
    s_add_u32 s16, s16, 0x2000
    buffer_load_dwordx4 v[132:135], v4, s[8:11], s16 offen nt
    s_waitcnt vmcnt(10)
    buffer_load_dwordx4 v[136:139], v5, s[8:11], s16 offen nt
    s_waitcnt vmcnt(10)
    buffer_load_dwordx4 v[140:143], v6, s[8:11], s16 offen nt
    s_waitcnt vmcnt(10)
    buffer_load_dwordx4 v[144:147], v7, s[8:11], s16 offen nt
    s_waitcnt vmcnt(10)
    s_add_u32 s16, s16, 0x2000
    buffer_load_dwordx4 v[148:151], v4, s[8:11], s16 offen nt
    s_waitcnt vmcnt(10)
    buffer_load_dwordx4 v[152:155], v5, s[8:11], s16 offen nt
    s_waitcnt vmcnt(10)
    buffer_load_dwordx4 v[156:159], v6, s[8:11], s16 offen nt
    s_waitcnt vmcnt(10)
    buffer_load_dwordx4 v[160:163], v7, s[8:11], s16 offen nt
    s_waitcnt vmcnt(10)
    s_add_u32 s16, s16, 0x2000
    buffer_load_dwordx4 v[164:167], v4, s[8:11], s16 offen nt
    s_waitcnt vmcnt(10)
    buffer_load_dwordx4 v[168:171], v5, s[8:11], s16 offen nt
    s_waitcnt vmcnt(10)
    buffer_load_dwordx4 v[172:175], v6, s[8:11], s16 offen nt
    s_barrier
    ds_read_b128 v[32:35], v44 offset:0
    ds_read_b128 v[36:39], v44 offset:128
    s_waitcnt lgkmcnt(0)
.p2align 6
L_k:
    s_waitcnt vmcnt(10)
    buffer_load_dwordx4 v[176:179], v7, s[8:11], s16 offen nt
    v_mfma_f32_4x4x4_16b_bf16 v[20:23], v[52:53], v[32:33], 0
    s_nop 1
    v_mfma_f32_4x4x4_16b_bf16 v[20:23], v[54:55], v[34:35], v[20:23]
    s_add_u32 s16, s16, 0x2000
    s_cmp_lt_u32 s16, s27
    s_cbranch_scc1 L_k_a32
    s_mov_b32 s87, 0
    s_branch L_seg
L_k_a32:
    s_waitcnt vmcnt(9)
    buffer_load_dwordx4 v[52:55], v4, s[8:11], s16 offen nt
    v_mfma_f32_4x4x4_16b_bf16 v[20:23], v[56:57], v[36:37], v[20:23]
    s_nop 1
    v_mfma_f32_4x4x4_16b_bf16 v[20:23], v[58:59], v[38:39], v[20:23]
    s_waitcnt vmcnt(10)
    buffer_load_dwordx4 v[56:59], v5, s[8:11], s16 offen nt
    v_mfma_f32_4x4x4_16b_bf16 v[24:27], v[60:61], v[32:33], 0
    s_nop 1
    v_mfma_f32_4x4x4_16b_bf16 v[24:27], v[62:63], v[34:35], v[24:27]
    v_mov_b32_dpp v28, v20 quad_perm:[0,0,0,0] row_mask:0xf bank_mask:0xf
    v_add_f32_dpp v28, v21, v28 quad_perm:[1,1,1,1] row_mask:0xf bank_mask:0xf
    v_add_f32_dpp v28, v22, v28 quad_perm:[2,2,2,2] row_mask:0xf bank_mask:0xf
    v_add_f32_dpp v28, v23, v28 quad_perm:[3,3,3,3] row_mask:0xf bank_mask:0xf
    s_waitcnt vmcnt(9)
    buffer_load_dwordx4 v[60:63], v6, s[8:11], s16 offen nt
    v_mfma_f32_4x4x4_16b_bf16 v[24:27], v[64:65], v[36:37], v[24:27]
    s_nop 1
    v_mfma_f32_4x4x4_16b_bf16 v[24:27], v[66:67], v[38:39], v[24:27]
    v_add_f32_dpp v28, v28, v28 row_half_mirror row_mask:0xf bank_mask:0xf
    s_nop 3
    v_mov_b32_dpp v29, v24 quad_perm:[0,0,0,0] row_mask:0xf bank_mask:0xf
    v_add_f32_dpp v29, v25, v29 quad_perm:[1,1,1,1] row_mask:0xf bank_mask:0xf
    v_add_f32_dpp v29, v26, v29 quad_perm:[2,2,2,2] row_mask:0xf bank_mask:0xf
    v_add_f32_dpp v29, v27, v29 quad_perm:[3,3,3,3] row_mask:0xf bank_mask:0xf
    s_nop 1
    v_add_f32_dpp v28, v29, v29 row_half_mirror row_mask:0xf bank_mask:0xa
    v_cvt_pk_bf16_f32 v28, v28, v28
    v_and_b32 v28, 0xffff0000, v28
    v_mul_f32 v28, s26, v28
    v_cvt_pk_bf16_f32 v28, v28, v28
    v_and_b32 v28, 0xffff0000, v28
    ds_write_b16_d16_hi v40, v28
    v_max_f32 v12, v12, v28
    v_add_u32 v40, 32, v40
    s_sub_u32 s23, s23, 1
    s_cmp_eq_u32 s23, 0
    s_cbranch_scc1 L_kdone_4
    s_waitcnt vmcnt(10)
    buffer_load_dwordx4 v[64:67], v7, s[8:11], s16 offen nt
    v_mfma_f32_4x4x4_16b_bf16 v[20:23], v[68:69], v[32:33], 0
    s_nop 1
    v_mfma_f32_4x4x4_16b_bf16 v[20:23], v[70:71], v[34:35], v[20:23]
    s_add_u32 s16, s16, 0x2000
    s_cmp_lt_u32 s16, s27
    s_cbranch_scc1 L_k_a36
    s_mov_b32 s87, 1
    s_branch L_seg
L_k_a36:
    s_waitcnt vmcnt(9)
    buffer_load_dwordx4 v[68:71], v4, s[8:11], s16 offen nt
    v_mfma_f32_4x4x4_16b_bf16 v[20:23], v[72:73], v[36:37], v[20:23]
    s_nop 1
    v_mfma_f32_4x4x4_16b_bf16 v[20:23], v[74:75], v[38:39], v[20:23]
    s_waitcnt vmcnt(10)
    buffer_load_dwordx4 v[72:75], v5, s[8:11], s16 offen nt
    v_mfma_f32_4x4x4_16b_bf16 v[24:27], v[76:77], v[32:33], 0
    s_nop 1
    v_mfma_f32_4x4x4_16b_bf16 v[24:27], v[78:79], v[34:35], v[24:27]
    v_mov_b32_dpp v28, v20 quad_perm:[0,0,0,0] row_mask:0xf bank_mask:0xf
    v_add_f32_dpp v28, v21, v28 quad_perm:[1,1,1,1] row_mask:0xf bank_mask:0xf
    v_add_f32_dpp v28, v22, v28 quad_perm:[2,2,2,2] row_mask:0xf bank_mask:0xf
    v_add_f32_dpp v28, v23, v28 quad_perm:[3,3,3,3] row_mask:0xf bank_mask:0xf
    s_waitcnt vmcnt(9)
    buffer_load_dwordx4 v[76:79], v6, s[8:11], s16 offen nt
    v_mfma_f32_4x4x4_16b_bf16 v[24:27], v[80:81], v[36:37], v[24:27]
    s_nop 1
    v_mfma_f32_4x4x4_16b_bf16 v[24:27], v[82:83], v[38:39], v[24:27]
    v_add_f32_dpp v28, v28, v28 row_half_mirror row_mask:0xf bank_mask:0xf
    s_nop 3
    v_mov_b32_dpp v29, v24 quad_perm:[0,0,0,0] row_mask:0xf bank_mask:0xf
    v_add_f32_dpp v29, v25, v29 quad_perm:[1,1,1,1] row_mask:0xf bank_mask:0xf
    v_add_f32_dpp v29, v26, v29 quad_perm:[2,2,2,2] row_mask:0xf bank_mask:0xf
    v_add_f32_dpp v29, v27, v29 quad_perm:[3,3,3,3] row_mask:0xf bank_mask:0xf
    s_nop 1
    v_add_f32_dpp v28, v29, v29 row_half_mirror row_mask:0xf bank_mask:0xa
    v_cvt_pk_bf16_f32 v28, v28, v28
    v_and_b32 v28, 0xffff0000, v28
    v_mul_f32 v28, s26, v28
    v_cvt_pk_bf16_f32 v28, v28, v28
    v_and_b32 v28, 0xffff0000, v28
    ds_write_b16_d16_hi v40, v28
    v_max_f32 v12, v12, v28
    v_add_u32 v40, 32, v40
    s_sub_u32 s23, s23, 1
    s_cmp_eq_u32 s23, 0
    s_cbranch_scc1 L_kdone_8
    s_waitcnt vmcnt(10)
    buffer_load_dwordx4 v[80:83], v7, s[8:11], s16 offen nt
    v_mfma_f32_4x4x4_16b_bf16 v[20:23], v[84:85], v[32:33], 0
    s_nop 1
    v_mfma_f32_4x4x4_16b_bf16 v[20:23], v[86:87], v[34:35], v[20:23]
    s_add_u32 s16, s16, 0x2000
    s_cmp_lt_u32 s16, s27
    s_cbranch_scc1 L_k_a40
    s_mov_b32 s87, 2
    s_branch L_seg
L_k_a40:
    s_waitcnt vmcnt(9)
    buffer_load_dwordx4 v[84:87], v4, s[8:11], s16 offen nt
    v_mfma_f32_4x4x4_16b_bf16 v[20:23], v[88:89], v[36:37], v[20:23]
    s_nop 1
    v_mfma_f32_4x4x4_16b_bf16 v[20:23], v[90:91], v[38:39], v[20:23]
    s_waitcnt vmcnt(10)
    buffer_load_dwordx4 v[88:91], v5, s[8:11], s16 offen nt
    v_mfma_f32_4x4x4_16b_bf16 v[24:27], v[92:93], v[32:33], 0
    s_nop 1
    v_mfma_f32_4x4x4_16b_bf16 v[24:27], v[94:95], v[34:35], v[24:27]
    v_mov_b32_dpp v28, v20 quad_perm:[0,0,0,0] row_mask:0xf bank_mask:0xf
    v_add_f32_dpp v28, v21, v28 quad_perm:[1,1,1,1] row_mask:0xf bank_mask:0xf
    v_add_f32_dpp v28, v22, v28 quad_perm:[2,2,2,2] row_mask:0xf bank_mask:0xf
    v_add_f32_dpp v28, v23, v28 quad_perm:[3,3,3,3] row_mask:0xf bank_mask:0xf
    s_waitcnt vmcnt(9)
    buffer_load_dwordx4 v[92:95], v6, s[8:11], s16 offen nt
    v_mfma_f32_4x4x4_16b_bf16 v[24:27], v[96:97], v[36:37], v[24:27]
    s_nop 1
    v_mfma_f32_4x4x4_16b_bf16 v[24:27], v[98:99], v[38:39], v[24:27]
    v_add_f32_dpp v28, v28, v28 row_half_mirror row_mask:0xf bank_mask:0xf
    s_nop 3
    v_mov_b32_dpp v29, v24 quad_perm:[0,0,0,0] row_mask:0xf bank_mask:0xf
    v_add_f32_dpp v29, v25, v29 quad_perm:[1,1,1,1] row_mask:0xf bank_mask:0xf
    v_add_f32_dpp v29, v26, v29 quad_perm:[2,2,2,2] row_mask:0xf bank_mask:0xf
    v_add_f32_dpp v29, v27, v29 quad_perm:[3,3,3,3] row_mask:0xf bank_mask:0xf
    s_nop 1
    v_add_f32_dpp v28, v29, v29 row_half_mirror row_mask:0xf bank_mask:0xa
    v_cvt_pk_bf16_f32 v28, v28, v28
    v_and_b32 v28, 0xffff0000, v28
    v_mul_f32 v28, s26, v28
    v_cvt_pk_bf16_f32 v28, v28, v28
    v_and_b32 v28, 0xffff0000, v28
    ds_write_b16_d16_hi v40, v28
    v_max_f32 v12, v12, v28
    v_add_u32 v40, 32, v40
    s_sub_u32 s23, s23, 1
    s_cmp_eq_u32 s23, 0
    s_cbranch_scc1 L_kdone_12
    s_waitcnt vmcnt(10)
    buffer_load_dwordx4 v[96:99], v7, s[8:11], s16 offen nt
    v_mfma_f32_4x4x4_16b_bf16 v[20:23], v[100:101], v[32:33], 0
    s_nop 1
    v_mfma_f32_4x4x4_16b_bf16 v[20:23], v[102:103], v[34:35], v[20:23]
    s_add_u32 s16, s16, 0x2000
    s_cmp_lt_u32 s16, s27
    s_cbranch_scc1 L_k_a44
    s_mov_b32 s87, 3
    s_branch L_seg
L_k_a44:
    s_waitcnt vmcnt(9)
    buffer_load_dwordx4 v[100:103], v4, s[8:11], s16 offen nt
    v_mfma_f32_4x4x4_16b_bf16 v[20:23], v[104:105], v[36:37], v[20:23]
    s_nop 1
    v_mfma_f32_4x4x4_16b_bf16 v[20:23], v[106:107], v[38:39], v[20:23]
    s_waitcnt vmcnt(10)
    buffer_load_dwordx4 v[104:107], v5, s[8:11], s16 offen nt
    v_mfma_f32_4x4x4_16b_bf16 v[24:27], v[108:109], v[32:33], 0
    s_nop 1
    v_mfma_f32_4x4x4_16b_bf16 v[24:27], v[110:111], v[34:35], v[24:27]
    v_mov_b32_dpp v28, v20 quad_perm:[0,0,0,0] row_mask:0xf bank_mask:0xf
    v_add_f32_dpp v28, v21, v28 quad_perm:[1,1,1,1] row_mask:0xf bank_mask:0xf
    v_add_f32_dpp v28, v22, v28 quad_perm:[2,2,2,2] row_mask:0xf bank_mask:0xf
    v_add_f32_dpp v28, v23, v28 quad_perm:[3,3,3,3] row_mask:0xf bank_mask:0xf
    s_waitcnt vmcnt(9)
    buffer_load_dwordx4 v[108:111], v6, s[8:11], s16 offen nt
    v_mfma_f32_4x4x4_16b_bf16 v[24:27], v[112:113], v[36:37], v[24:27]
    s_nop 1
    v_mfma_f32_4x4x4_16b_bf16 v[24:27], v[114:115], v[38:39], v[24:27]
    v_add_f32_dpp v28, v28, v28 row_half_mirror row_mask:0xf bank_mask:0xf
    s_nop 3
    v_mov_b32_dpp v29, v24 quad_perm:[0,0,0,0] row_mask:0xf bank_mask:0xf
    v_add_f32_dpp v29, v25, v29 quad_perm:[1,1,1,1] row_mask:0xf bank_mask:0xf
    v_add_f32_dpp v29, v26, v29 quad_perm:[2,2,2,2] row_mask:0xf bank_mask:0xf
    v_add_f32_dpp v29, v27, v29 quad_perm:[3,3,3,3] row_mask:0xf bank_mask:0xf
    s_nop 1
    v_add_f32_dpp v28, v29, v29 row_half_mirror row_mask:0xf bank_mask:0xa
    v_cvt_pk_bf16_f32 v28, v28, v28
    v_and_b32 v28, 0xffff0000, v28
    v_mul_f32 v28, s26, v28
    v_cvt_pk_bf16_f32 v28, v28, v28
    v_and_b32 v28, 0xffff0000, v28
    ds_write_b16_d16_hi v40, v28
    v_max_f32 v12, v12, v28
    v_add_u32 v40, 32, v40
    s_sub_u32 s23, s23, 1
    s_cmp_eq_u32 s23, 0
    s_cbranch_scc1 L_kdone_16
    s_waitcnt vmcnt(10)
    buffer_load_dwordx4 v[112:115], v7, s[8:11], s16 offen nt
    v_mfma_f32_4x4x4_16b_bf16 v[20:23], v[116:117], v[32:33], 0
    s_nop 1
    v_mfma_f32_4x4x4_16b_bf16 v[20:23], v[118:119], v[34:35], v[20:23]
    s_add_u32 s16, s16, 0x2000
    s_cmp_lt_u32 s16, s27
    s_cbranch_scc1 L_k_a48
    s_mov_b32 s87, 4
    s_branch L_seg
L_k_a48:
    s_waitcnt vmcnt(9)
    buffer_load_dwordx4 v[116:119], v4, s[8:11], s16 offen nt
    v_mfma_f32_4x4x4_16b_bf16 v[20:23], v[120:121], v[36:37], v[20:23]
    s_nop 1
    v_mfma_f32_4x4x4_16b_bf16 v[20:23], v[122:123], v[38:39], v[20:23]
    s_waitcnt vmcnt(10)
    buffer_load_dwordx4 v[120:123], v5, s[8:11], s16 offen nt
    v_mfma_f32_4x4x4_16b_bf16 v[24:27], v[124:125], v[32:33], 0
    s_nop 1
    v_mfma_f32_4x4x4_16b_bf16 v[24:27], v[126:127], v[34:35], v[24:27]
    v_mov_b32_dpp v28, v20 quad_perm:[0,0,0,0] row_mask:0xf bank_mask:0xf
    v_add_f32_dpp v28, v21, v28 quad_perm:[1,1,1,1] row_mask:0xf bank_mask:0xf
    v_add_f32_dpp v28, v22, v28 quad_perm:[2,2,2,2] row_mask:0xf bank_mask:0xf
    v_add_f32_dpp v28, v23, v28 quad_perm:[3,3,3,3] row_mask:0xf bank_mask:0xf
    s_waitcnt vmcnt(9)
    buffer_load_dwordx4 v[124:127], v6, s[8:11], s16 offen nt
    v_mfma_f32_4x4x4_16b_bf16 v[24:27], v[128:129], v[36:37], v[24:27]
    s_nop 1
    v_mfma_f32_4x4x4_16b_bf16 v[24:27], v[130:131], v[38:39], v[24:27]
    v_add_f32_dpp v28, v28, v28 row_half_mirror row_mask:0xf bank_mask:0xf
    s_nop 3
    v_mov_b32_dpp v29, v24 quad_perm:[0,0,0,0] row_mask:0xf bank_mask:0xf
    v_add_f32_dpp v29, v25, v29 quad_perm:[1,1,1,1] row_mask:0xf bank_mask:0xf
    v_add_f32_dpp v29, v26, v29 quad_perm:[2,2,2,2] row_mask:0xf bank_mask:0xf
    v_add_f32_dpp v29, v27, v29 quad_perm:[3,3,3,3] row_mask:0xf bank_mask:0xf
    s_nop 1
    v_add_f32_dpp v28, v29, v29 row_half_mirror row_mask:0xf bank_mask:0xa
    v_cvt_pk_bf16_f32 v28, v28, v28
    v_and_b32 v28, 0xffff0000, v28
    v_mul_f32 v28, s26, v28
    v_cvt_pk_bf16_f32 v28, v28, v28
    v_and_b32 v28, 0xffff0000, v28
    ds_write_b16_d16_hi v40, v28
    v_max_f32 v12, v12, v28
    v_add_u32 v40, 32, v40
    s_sub_u32 s23, s23, 1
    s_cmp_eq_u32 s23, 0
    s_cbranch_scc1 L_kdone_20
    s_waitcnt vmcnt(10)
    buffer_load_dwordx4 v[128:131], v7, s[8:11], s16 offen nt
    v_mfma_f32_4x4x4_16b_bf16 v[20:23], v[132:133], v[32:33], 0
    s_nop 1
    v_mfma_f32_4x4x4_16b_bf16 v[20:23], v[134:135], v[34:35], v[20:23]
    s_add_u32 s16, s16, 0x2000
    s_cmp_lt_u32 s16, s27
    s_cbranch_scc1 L_k_a52
    s_mov_b32 s87, 5
    s_branch L_seg
L_k_a52:
    s_waitcnt vmcnt(9)
    buffer_load_dwordx4 v[132:135], v4, s[8:11], s16 offen nt
    v_mfma_f32_4x4x4_16b_bf16 v[20:23], v[136:137], v[36:37], v[20:23]
    s_nop 1
    v_mfma_f32_4x4x4_16b_bf16 v[20:23], v[138:139], v[38:39], v[20:23]
    s_waitcnt vmcnt(10)
    buffer_load_dwordx4 v[136:139], v5, s[8:11], s16 offen nt
    v_mfma_f32_4x4x4_16b_bf16 v[24:27], v[140:141], v[32:33], 0
    s_nop 1
    v_mfma_f32_4x4x4_16b_bf16 v[24:27], v[142:143], v[34:35], v[24:27]
    v_mov_b32_dpp v28, v20 quad_perm:[0,0,0,0] row_mask:0xf bank_mask:0xf
    v_add_f32_dpp v28, v21, v28 quad_perm:[1,1,1,1] row_mask:0xf bank_mask:0xf
    v_add_f32_dpp v28, v22, v28 quad_perm:[2,2,2,2] row_mask:0xf bank_mask:0xf
    v_add_f32_dpp v28, v23, v28 quad_perm:[3,3,3,3] row_mask:0xf bank_mask:0xf
    s_waitcnt vmcnt(9)
    buffer_load_dwordx4 v[140:143], v6, s[8:11], s16 offen nt
    v_mfma_f32_4x4x4_16b_bf16 v[24:27], v[144:145], v[36:37], v[24:27]
    s_nop 1
    v_mfma_f32_4x4x4_16b_bf16 v[24:27], v[146:147], v[38:39], v[24:27]
    v_add_f32_dpp v28, v28, v28 row_half_mirror row_mask:0xf bank_mask:0xf
    s_nop 3
    v_mov_b32_dpp v29, v24 quad_perm:[0,0,0,0] row_mask:0xf bank_mask:0xf
    v_add_f32_dpp v29, v25, v29 quad_perm:[1,1,1,1] row_mask:0xf bank_mask:0xf
    v_add_f32_dpp v29, v26, v29 quad_perm:[2,2,2,2] row_mask:0xf bank_mask:0xf
    v_add_f32_dpp v29, v27, v29 quad_perm:[3,3,3,3] row_mask:0xf bank_mask:0xf
    s_nop 1
    v_add_f32_dpp v28, v29, v29 row_half_mirror row_mask:0xf bank_mask:0xa
    v_cvt_pk_bf16_f32 v28, v28, v28
    v_and_b32 v28, 0xffff0000, v28
    v_mul_f32 v28, s26, v28
    v_cvt_pk_bf16_f32 v28, v28, v28
    v_and_b32 v28, 0xffff0000, v28
    ds_write_b16_d16_hi v40, v28
    v_max_f32 v12, v12, v28
    v_add_u32 v40, 32, v40
    s_sub_u32 s23, s23, 1
    s_cmp_eq_u32 s23, 0
    s_cbranch_scc1 L_kdone_24
    s_waitcnt vmcnt(10)
    buffer_load_dwordx4 v[144:147], v7, s[8:11], s16 offen nt
    v_mfma_f32_4x4x4_16b_bf16 v[20:23], v[148:149], v[32:33], 0
    s_nop 1
    v_mfma_f32_4x4x4_16b_bf16 v[20:23], v[150:151], v[34:35], v[20:23]
    s_add_u32 s16, s16, 0x2000
    s_cmp_lt_u32 s16, s27
    s_cbranch_scc1 L_k_a56
    s_mov_b32 s87, 6
    s_branch L_seg
L_k_a56:
    s_waitcnt vmcnt(9)
    buffer_load_dwordx4 v[148:151], v4, s[8:11], s16 offen nt
    v_mfma_f32_4x4x4_16b_bf16 v[20:23], v[152:153], v[36:37], v[20:23]
    s_nop 1
    v_mfma_f32_4x4x4_16b_bf16 v[20:23], v[154:155], v[38:39], v[20:23]
    s_waitcnt vmcnt(10)
    buffer_load_dwordx4 v[152:155], v5, s[8:11], s16 offen nt
    v_mfma_f32_4x4x4_16b_bf16 v[24:27], v[156:157], v[32:33], 0
    s_nop 1
    v_mfma_f32_4x4x4_16b_bf16 v[24:27], v[158:159], v[34:35], v[24:27]
    v_mov_b32_dpp v28, v20 quad_perm:[0,0,0,0] row_mask:0xf bank_mask:0xf
    v_add_f32_dpp v28, v21, v28 quad_perm:[1,1,1,1] row_mask:0xf bank_mask:0xf
    v_add_f32_dpp v28, v22, v28 quad_perm:[2,2,2,2] row_mask:0xf bank_mask:0xf
    v_add_f32_dpp v28, v23, v28 quad_perm:[3,3,3,3] row_mask:0xf bank_mask:0xf
    s_waitcnt vmcnt(9)
    buffer_load_dwordx4 v[156:159], v6, s[8:11], s16 offen nt
    v_mfma_f32_4x4x4_16b_bf16 v[24:27], v[160:161], v[36:37], v[24:27]
    s_nop 1
    v_mfma_f32_4x4x4_16b_bf16 v[24:27], v[162:163], v[38:39], v[24:27]
    v_add_f32_dpp v28, v28, v28 row_half_mirror row_mask:0xf bank_mask:0xf
    s_nop 3
    v_mov_b32_dpp v29, v24 quad_perm:[0,0,0,0] row_mask:0xf bank_mask:0xf
    v_add_f32_dpp v29, v25, v29 quad_perm:[1,1,1,1] row_mask:0xf bank_mask:0xf
    v_add_f32_dpp v29, v26, v29 quad_perm:[2,2,2,2] row_mask:0xf bank_mask:0xf
    v_add_f32_dpp v29, v27, v29 quad_perm:[3,3,3,3] row_mask:0xf bank_mask:0xf
    s_nop 1
    v_add_f32_dpp v28, v29, v29 row_half_mirror row_mask:0xf bank_mask:0xa
    v_cvt_pk_bf16_f32 v28, v28, v28
    v_and_b32 v28, 0xffff0000, v28
    v_mul_f32 v28, s26, v28
    v_cvt_pk_bf16_f32 v28, v28, v28
    v_and_b32 v28, 0xffff0000, v28
    ds_write_b16_d16_hi v40, v28
    v_max_f32 v12, v12, v28
    v_add_u32 v40, 32, v40
    s_sub_u32 s23, s23, 1
    s_cmp_eq_u32 s23, 0
    s_cbranch_scc1 L_kdone_28
    s_waitcnt vmcnt(10)
    buffer_load_dwordx4 v[160:163], v7, s[8:11], s16 offen nt
    v_mfma_f32_4x4x4_16b_bf16 v[20:23], v[164:165], v[32:33], 0
    s_nop 1
    v_mfma_f32_4x4x4_16b_bf16 v[20:23], v[166:167], v[34:35], v[20:23]
    s_add_u32 s16, s16, 0x2000
    s_cmp_lt_u32 s16, s27
    s_cbranch_scc1 L_k_a60
    s_mov_b32 s87, 7
    s_branch L_seg
L_k_a60:
    s_waitcnt vmcnt(9)
    buffer_load_dwordx4 v[164:167], v4, s[8:11], s16 offen nt
    v_mfma_f32_4x4x4_16b_bf16 v[20:23], v[168:169], v[36:37], v[20:23]
    s_nop 1
    v_mfma_f32_4x4x4_16b_bf16 v[20:23], v[170:171], v[38:39], v[20:23]
    s_waitcnt vmcnt(10)
    buffer_load_dwordx4 v[168:171], v5, s[8:11], s16 offen nt
    v_mfma_f32_4x4x4_16b_bf16 v[24:27], v[172:173], v[32:33], 0
    s_nop 1
    v_mfma_f32_4x4x4_16b_bf16 v[24:27], v[174:175], v[34:35], v[24:27]
    v_mov_b32_dpp v28, v20 quad_perm:[0,0,0,0] row_mask:0xf bank_mask:0xf
    v_add_f32_dpp v28, v21, v28 quad_perm:[1,1,1,1] row_mask:0xf bank_mask:0xf
    v_add_f32_dpp v28, v22, v28 quad_perm:[2,2,2,2] row_mask:0xf bank_mask:0xf
    v_add_f32_dpp v28, v23, v28 quad_perm:[3,3,3,3] row_mask:0xf bank_mask:0xf
    s_waitcnt vmcnt(9)
    buffer_load_dwordx4 v[172:175], v6, s[8:11], s16 offen nt
    v_mfma_f32_4x4x4_16b_bf16 v[24:27], v[176:177], v[36:37], v[24:27]
    s_nop 1
    v_mfma_f32_4x4x4_16b_bf16 v[24:27], v[178:179], v[38:39], v[24:27]
    v_add_f32_dpp v28, v28, v28 row_half_mirror row_mask:0xf bank_mask:0xf
    s_nop 3
    v_mov_b32_dpp v29, v24 quad_perm:[0,0,0,0] row_mask:0xf bank_mask:0xf
    v_add_f32_dpp v29, v25, v29 quad_perm:[1,1,1,1] row_mask:0xf bank_mask:0xf
    v_add_f32_dpp v29, v26, v29 quad_perm:[2,2,2,2] row_mask:0xf bank_mask:0xf
    v_add_f32_dpp v29, v27, v29 quad_perm:[3,3,3,3] row_mask:0xf bank_mask:0xf
    s_nop 1
    v_add_f32_dpp v28, v29, v29 row_half_mirror row_mask:0xf bank_mask:0xa
    v_cvt_pk_bf16_f32 v28, v28, v28
    v_and_b32 v28, 0xffff0000, v28
    v_mul_f32 v28, s26, v28
    v_cvt_pk_bf16_f32 v28, v28, v28
    v_and_b32 v28, 0xffff0000, v28
    ds_write_b16_d16_hi v40, v28
    v_max_f32 v12, v12, v28
    v_add_u32 v40, 32, v40
    s_sub_u32 s23, s23, 1
    s_cmp_eq_u32 s23, 0
    s_cbranch_scc1 L_kdone_0
    s_branch L_k
L_kdone_0:
    s_mov_b32 s19, 0
    s_branch L_kd
L_kdone_4:
    s_mov_b32 s19, 4
    s_branch L_kd
L_kdone_8:
    s_mov_b32 s19, 8
    s_branch L_kd
L_kdone_12:
    s_mov_b32 s19, 12
    s_branch L_kd
L_kdone_16:
    s_mov_b32 s19, 16
    s_branch L_kd
L_kdone_20:
    s_mov_b32 s19, 20
    s_branch L_kd
L_kdone_24:
    s_mov_b32 s19, 24
    s_branch L_kd
L_kdone_28:
    s_mov_b32 s19, 28
L_kd:
    v_max_f32_dpp v12, v12, v12 row_ror:4 row_mask:0xf bank_mask:0xf
    v_mov_b32 v21, 0
    s_waitcnt lgkmcnt(0)
    ds_read_u16_d16_hi v21, v41
    v_max_f32_dpp v12, v12, v12 row_ror:8 row_mask:0xf bank_mask:0xf
    v_mov_b32 v28, v12
    s_nop 1
    v_permlane16_swap_b32 v28, v12
    v_max_f32 v12, v28, v12
    v_mov_b32 v28, v12
    s_nop 1
    v_permlane32_swap_b32 v28, v12
    v_max_f32 v12, v28, v12
    s_mov_b32 s23, s15
    s_waitcnt lgkmcnt(0)
    v_sub_f32 v20, v21, v12
    ds_read_u16_d16_hi v21, v41 offset:32
    v_mul_f32 v20, s24, v20
    v_add_u32 v41, 32, v41
    v_exp_f32 v20, v20
    s_cmp_eq_u32 s19, 4
    s_cbranch_scc1 L_v_4
    s_cmp_eq_u32 s19, 8
    s_cbranch_scc1 L_v_8
    s_cmp_eq_u32 s19, 12
    s_cbranch_scc1 L_v_12
    s_cmp_eq_u32 s19, 16
    s_cbranch_scc1 L_v_16
    s_cmp_eq_u32 s19, 20
    s_cbranch_scc1 L_v_20
    s_cmp_eq_u32 s19, 24
    s_cbranch_scc1 L_v_24
    s_cmp_eq_u32 s19, 28
    s_cbranch_scc1 L_v_28
L_v:
L_v_0:
    s_waitcnt vmcnt(10)
    buffer_load_dwordx4 v[176:179], v7, s[8:11], s16 offen nt
    v_cvt_pk_bf16_f32 v28, v20, v20
    v_add_f32 v13, v13, v20
    s_nop 0
    v_and_b32_dpp v44, v28, v8 row_newbcast:0 row_mask:0xf bank_mask:0xf
    v_and_b32_dpp v45, v28, v9 row_newbcast:0 row_mask:0xf bank_mask:0xf
    v_and_b32_dpp v46, v28, v10 row_newbcast:0 row_mask:0xf bank_mask:0xf
    v_and_b32_dpp v47, v28, v11 row_newbcast:0 row_mask:0xf bank_mask:0xf
    v_and_b32_dpp v48, v28, v8 row_newbcast:4 row_mask:0xf bank_mask:0xf
    v_and_b32_dpp v49, v28, v9 row_newbcast:4 row_mask:0xf bank_mask:0xf
    v_and_b32_dpp v50, v28, v10 row_newbcast:4 row_mask:0xf bank_mask:0xf
    v_and_b32_dpp v51, v28, v11 row_newbcast:4 row_mask:0xf bank_mask:0xf
    v_mfma_f32_16x16x32_bf16 v[16:19], v[44:47], v[52:55], v[16:19]
    s_add_u32 s16, s16, 0x2000
    s_cmp_lt_u32 s16, s27
    s_cbranch_scc1 L_v_a32
    s_mov_b32 s87, 8
    s_branch L_seg
L_v_a32:
    s_waitcnt vmcnt(9)
    buffer_load_dwordx4 v[52:55], v4, s[8:11], s16 offen nt
    v_and_b32_dpp v44, v28, v8 row_newbcast:8 row_mask:0xf bank_mask:0xf
    v_and_b32_dpp v45, v28, v9 row_newbcast:8 row_mask:0xf bank_mask:0xf
    v_and_b32_dpp v46, v28, v10 row_newbcast:8 row_mask:0xf bank_mask:0xf
    v_and_b32_dpp v47, v28, v11 row_newbcast:8 row_mask:0xf bank_mask:0xf
    v_mfma_f32_16x16x32_bf16 v[16:19], v[48:51], v[56:59], v[16:19]
    s_waitcnt lgkmcnt(0)
    v_sub_f32 v20, v21, v12
    ds_read_u16_d16_hi v21, v41 offset:32
    v_mul_f32 v20, s24, v20
    v_add_u32 v41, 32, v41
    v_exp_f32 v20, v20
    s_waitcnt vmcnt(10)
    buffer_load_dwordx4 v[56:59], v5, s[8:11], s16 offen nt
    v_and_b32_dpp v48, v28, v8 row_newbcast:12 row_mask:0xf bank_mask:0xf
    v_and_b32_dpp v49, v28, v9 row_newbcast:12 row_mask:0xf bank_mask:0xf
    v_and_b32_dpp v50, v28, v10 row_newbcast:12 row_mask:0xf bank_mask:0xf
    v_and_b32_dpp v51, v28, v11 row_newbcast:12 row_mask:0xf bank_mask:0xf
    v_mfma_f32_16x16x32_bf16 v[16:19], v[44:47], v[60:63], v[16:19]
    s_waitcnt vmcnt(10)
    buffer_load_dwordx4 v[60:63], v6, s[8:11], s16 offen nt
    v_mfma_f32_16x16x32_bf16 v[16:19], v[48:51], v[64:67], v[16:19]
    s_sub_u32 s23, s23, 1
    s_cmp_le_u32 s23, s77
    s_cbranch_scc1 L_rk_4
L_v_4:
    s_waitcnt vmcnt(10)
    buffer_load_dwordx4 v[64:67], v7, s[8:11], s16 offen nt
    v_cvt_pk_bf16_f32 v28, v20, v20
    v_add_f32 v13, v13, v20
    s_nop 0
    v_and_b32_dpp v44, v28, v8 row_newbcast:0 row_mask:0xf bank_mask:0xf
    v_and_b32_dpp v45, v28, v9 row_newbcast:0 row_mask:0xf bank_mask:0xf
    v_and_b32_dpp v46, v28, v10 row_newbcast:0 row_mask:0xf bank_mask:0xf
    v_and_b32_dpp v47, v28, v11 row_newbcast:0 row_mask:0xf bank_mask:0xf
    v_and_b32_dpp v48, v28, v8 row_newbcast:4 row_mask:0xf bank_mask:0xf
    v_and_b32_dpp v49, v28, v9 row_newbcast:4 row_mask:0xf bank_mask:0xf
    v_and_b32_dpp v50, v28, v10 row_newbcast:4 row_mask:0xf bank_mask:0xf
    v_and_b32_dpp v51, v28, v11 row_newbcast:4 row_mask:0xf bank_mask:0xf
    v_mfma_f32_16x16x32_bf16 v[16:19], v[44:47], v[68:71], v[16:19]
    s_add_u32 s16, s16, 0x2000
    s_cmp_lt_u32 s16, s27
    s_cbranch_scc1 L_v_a36
    s_mov_b32 s87, 9
    s_branch L_seg
L_v_a36:
    s_waitcnt vmcnt(9)
    buffer_load_dwordx4 v[68:71], v4, s[8:11], s16 offen nt
    v_and_b32_dpp v44, v28, v8 row_newbcast:8 row_mask:0xf bank_mask:0xf
    v_and_b32_dpp v45, v28, v9 row_newbcast:8 row_mask:0xf bank_mask:0xf
    v_and_b32_dpp v46, v28, v10 row_newbcast:8 row_mask:0xf bank_mask:0xf
    v_and_b32_dpp v47, v28, v11 row_newbcast:8 row_mask:0xf bank_mask:0xf
    v_mfma_f32_16x16x32_bf16 v[16:19], v[48:51], v[72:75], v[16:19]
    s_waitcnt lgkmcnt(0)
    v_sub_f32 v20, v21, v12
    ds_read_u16_d16_hi v21, v41 offset:32
    v_mul_f32 v20, s24, v20
    v_add_u32 v41, 32, v41
    v_exp_f32 v20, v20
    s_waitcnt vmcnt(10)
    buffer_load_dwordx4 v[72:75], v5, s[8:11], s16 offen nt
    v_and_b32_dpp v48, v28, v8 row_newbcast:12 row_mask:0xf bank_mask:0xf
    v_and_b32_dpp v49, v28, v9 row_newbcast:12 row_mask:0xf bank_mask:0xf
    v_and_b32_dpp v50, v28, v10 row_newbcast:12 row_mask:0xf bank_mask:0xf
    v_and_b32_dpp v51, v28, v11 row_newbcast:12 row_mask:0xf bank_mask:0xf
    v_mfma_f32_16x16x32_bf16 v[16:19], v[44:47], v[76:79], v[16:19]
    s_waitcnt vmcnt(10)
    buffer_load_dwordx4 v[76:79], v6, s[8:11], s16 offen nt
    v_mfma_f32_16x16x32_bf16 v[16:19], v[48:51], v[80:83], v[16:19]
    s_sub_u32 s23, s23, 1
    s_cmp_le_u32 s23, s77
    s_cbranch_scc1 L_rk_8
L_v_8:
    s_waitcnt vmcnt(10)
    buffer_load_dwordx4 v[80:83], v7, s[8:11], s16 offen nt
    v_cvt_pk_bf16_f32 v28, v20, v20
    v_add_f32 v13, v13, v20
    s_nop 0
    v_and_b32_dpp v44, v28, v8 row_newbcast:0 row_mask:0xf bank_mask:0xf
    v_and_b32_dpp v45, v28, v9 row_newbcast:0 row_mask:0xf bank_mask:0xf
    v_and_b32_dpp v46, v28, v10 row_newbcast:0 row_mask:0xf bank_mask:0xf
    v_and_b32_dpp v47, v28, v11 row_newbcast:0 row_mask:0xf bank_mask:0xf
    v_and_b32_dpp v48, v28, v8 row_newbcast:4 row_mask:0xf bank_mask:0xf
    v_and_b32_dpp v49, v28, v9 row_newbcast:4 row_mask:0xf bank_mask:0xf
    v_and_b32_dpp v50, v28, v10 row_newbcast:4 row_mask:0xf bank_mask:0xf
    v_and_b32_dpp v51, v28, v11 row_newbcast:4 row_mask:0xf bank_mask:0xf
    v_mfma_f32_16x16x32_bf16 v[16:19], v[44:47], v[84:87], v[16:19]
    s_add_u32 s16, s16, 0x2000
    s_cmp_lt_u32 s16, s27
    s_cbranch_scc1 L_v_a40
    s_mov_b32 s87, 10
    s_branch L_seg
L_v_a40:
    s_waitcnt vmcnt(9)
    buffer_load_dwordx4 v[84:87], v4, s[8:11], s16 offen nt
    v_and_b32_dpp v44, v28, v8 row_newbcast:8 row_mask:0xf bank_mask:0xf
    v_and_b32_dpp v45, v28, v9 row_newbcast:8 row_mask:0xf bank_mask:0xf
    v_and_b32_dpp v46, v28, v10 row_newbcast:8 row_mask:0xf bank_mask:0xf
    v_and_b32_dpp v47, v28, v11 row_newbcast:8 row_mask:0xf bank_mask:0xf
    v_mfma_f32_16x16x32_bf16 v[16:19], v[48:51], v[88:91], v[16:19]
    s_waitcnt lgkmcnt(0)
    v_sub_f32 v20, v21, v12
    ds_read_u16_d16_hi v21, v41 offset:32
    v_mul_f32 v20, s24, v20
    v_add_u32 v41, 32, v41
    v_exp_f32 v20, v20
    s_waitcnt vmcnt(10)
    buffer_load_dwordx4 v[88:91], v5, s[8:11], s16 offen nt
    v_and_b32_dpp v48, v28, v8 row_newbcast:12 row_mask:0xf bank_mask:0xf
    v_and_b32_dpp v49, v28, v9 row_newbcast:12 row_mask:0xf bank_mask:0xf
    v_and_b32_dpp v50, v28, v10 row_newbcast:12 row_mask:0xf bank_mask:0xf
    v_and_b32_dpp v51, v28, v11 row_newbcast:12 row_mask:0xf bank_mask:0xf
    v_mfma_f32_16x16x32_bf16 v[16:19], v[44:47], v[92:95], v[16:19]
    s_waitcnt vmcnt(10)
    buffer_load_dwordx4 v[92:95], v6, s[8:11], s16 offen nt
    v_mfma_f32_16x16x32_bf16 v[16:19], v[48:51], v[96:99], v[16:19]
    s_sub_u32 s23, s23, 1
    s_cmp_le_u32 s23, s77
    s_cbranch_scc1 L_rk_12
L_v_12:
    s_waitcnt vmcnt(10)
    buffer_load_dwordx4 v[96:99], v7, s[8:11], s16 offen nt
    v_cvt_pk_bf16_f32 v28, v20, v20
    v_add_f32 v13, v13, v20
    s_nop 0
    v_and_b32_dpp v44, v28, v8 row_newbcast:0 row_mask:0xf bank_mask:0xf
    v_and_b32_dpp v45, v28, v9 row_newbcast:0 row_mask:0xf bank_mask:0xf
    v_and_b32_dpp v46, v28, v10 row_newbcast:0 row_mask:0xf bank_mask:0xf
    v_and_b32_dpp v47, v28, v11 row_newbcast:0 row_mask:0xf bank_mask:0xf
    v_and_b32_dpp v48, v28, v8 row_newbcast:4 row_mask:0xf bank_mask:0xf
    v_and_b32_dpp v49, v28, v9 row_newbcast:4 row_mask:0xf bank_mask:0xf
    v_and_b32_dpp v50, v28, v10 row_newbcast:4 row_mask:0xf bank_mask:0xf
    v_and_b32_dpp v51, v28, v11 row_newbcast:4 row_mask:0xf bank_mask:0xf
    v_mfma_f32_16x16x32_bf16 v[16:19], v[44:47], v[100:103], v[16:19]
    s_add_u32 s16, s16, 0x2000
    s_cmp_lt_u32 s16, s27
    s_cbranch_scc1 L_v_a44
    s_mov_b32 s87, 11
    s_branch L_seg
L_v_a44:
    s_waitcnt vmcnt(9)
    buffer_load_dwordx4 v[100:103], v4, s[8:11], s16 offen nt
    v_and_b32_dpp v44, v28, v8 row_newbcast:8 row_mask:0xf bank_mask:0xf
    v_and_b32_dpp v45, v28, v9 row_newbcast:8 row_mask:0xf bank_mask:0xf
    v_and_b32_dpp v46, v28, v10 row_newbcast:8 row_mask:0xf bank_mask:0xf
    v_and_b32_dpp v47, v28, v11 row_newbcast:8 row_mask:0xf bank_mask:0xf
    v_mfma_f32_16x16x32_bf16 v[16:19], v[48:51], v[104:107], v[16:19]
    s_waitcnt lgkmcnt(0)
    v_sub_f32 v20, v21, v12
    ds_read_u16_d16_hi v21, v41 offset:32
    v_mul_f32 v20, s24, v20
    v_add_u32 v41, 32, v41
    v_exp_f32 v20, v20
    s_waitcnt vmcnt(10)
    buffer_load_dwordx4 v[104:107], v5, s[8:11], s16 offen nt
    v_and_b32_dpp v48, v28, v8 row_newbcast:12 row_mask:0xf bank_mask:0xf
    v_and_b32_dpp v49, v28, v9 row_newbcast:12 row_mask:0xf bank_mask:0xf
    v_and_b32_dpp v50, v28, v10 row_newbcast:12 row_mask:0xf bank_mask:0xf
    v_and_b32_dpp v51, v28, v11 row_newbcast:12 row_mask:0xf bank_mask:0xf
    v_mfma_f32_16x16x32_bf16 v[16:19], v[44:47], v[108:111], v[16:19]
    s_waitcnt vmcnt(10)
    buffer_load_dwordx4 v[108:111], v6, s[8:11], s16 offen nt
    v_mfma_f32_16x16x32_bf16 v[16:19], v[48:51], v[112:115], v[16:19]
    s_sub_u32 s23, s23, 1
    s_cmp_le_u32 s23, s77
    s_cbranch_scc1 L_rk_16
L_v_16:
    s_waitcnt vmcnt(10)
    buffer_load_dwordx4 v[112:115], v7, s[8:11], s16 offen nt
    v_cvt_pk_bf16_f32 v28, v20, v20
    v_add_f32 v13, v13, v20
    s_nop 0
    v_and_b32_dpp v44, v28, v8 row_newbcast:0 row_mask:0xf bank_mask:0xf
    v_and_b32_dpp v45, v28, v9 row_newbcast:0 row_mask:0xf bank_mask:0xf
    v_and_b32_dpp v46, v28, v10 row_newbcast:0 row_mask:0xf bank_mask:0xf
    v_and_b32_dpp v47, v28, v11 row_newbcast:0 row_mask:0xf bank_mask:0xf
    v_and_b32_dpp v48, v28, v8 row_newbcast:4 row_mask:0xf bank_mask:0xf
    v_and_b32_dpp v49, v28, v9 row_newbcast:4 row_mask:0xf bank_mask:0xf
    v_and_b32_dpp v50, v28, v10 row_newbcast:4 row_mask:0xf bank_mask:0xf
    v_and_b32_dpp v51, v28, v11 row_newbcast:4 row_mask:0xf bank_mask:0xf
    v_mfma_f32_16x16x32_bf16 v[16:19], v[44:47], v[116:119], v[16:19]
    s_add_u32 s16, s16, 0x2000
    s_cmp_lt_u32 s16, s27
    s_cbranch_scc1 L_v_a48
    s_mov_b32 s87, 12
    s_branch L_seg
L_v_a48:
    s_waitcnt vmcnt(9)
    buffer_load_dwordx4 v[116:119], v4, s[8:11], s16 offen nt
    v_and_b32_dpp v44, v28, v8 row_newbcast:8 row_mask:0xf bank_mask:0xf
    v_and_b32_dpp v45, v28, v9 row_newbcast:8 row_mask:0xf bank_mask:0xf
    v_and_b32_dpp v46, v28, v10 row_newbcast:8 row_mask:0xf bank_mask:0xf
    v_and_b32_dpp v47, v28, v11 row_newbcast:8 row_mask:0xf bank_mask:0xf
    v_mfma_f32_16x16x32_bf16 v[16:19], v[48:51], v[120:123], v[16:19]
    s_waitcnt lgkmcnt(0)
    v_sub_f32 v20, v21, v12
    ds_read_u16_d16_hi v21, v41 offset:32
    v_mul_f32 v20, s24, v20
    v_add_u32 v41, 32, v41
    v_exp_f32 v20, v20
    s_waitcnt vmcnt(10)
    buffer_load_dwordx4 v[120:123], v5, s[8:11], s16 offen nt
    v_and_b32_dpp v48, v28, v8 row_newbcast:12 row_mask:0xf bank_mask:0xf
    v_and_b32_dpp v49, v28, v9 row_newbcast:12 row_mask:0xf bank_mask:0xf
    v_and_b32_dpp v50, v28, v10 row_newbcast:12 row_mask:0xf bank_mask:0xf
    v_and_b32_dpp v51, v28, v11 row_newbcast:12 row_mask:0xf bank_mask:0xf
    v_mfma_f32_16x16x32_bf16 v[16:19], v[44:47], v[124:127], v[16:19]
    s_waitcnt vmcnt(10)
    buffer_load_dwordx4 v[124:127], v6, s[8:11], s16 offen nt
    v_mfma_f32_16x16x32_bf16 v[16:19], v[48:51], v[128:131], v[16:19]
    s_sub_u32 s23, s23, 1
    s_cmp_le_u32 s23, s77
    s_cbranch_scc1 L_rk_20
L_v_20:
    s_waitcnt vmcnt(10)
    buffer_load_dwordx4 v[128:131], v7, s[8:11], s16 offen nt
    v_cvt_pk_bf16_f32 v28, v20, v20
    v_add_f32 v13, v13, v20
    s_nop 0
    v_and_b32_dpp v44, v28, v8 row_newbcast:0 row_mask:0xf bank_mask:0xf
    v_and_b32_dpp v45, v28, v9 row_newbcast:0 row_mask:0xf bank_mask:0xf
    v_and_b32_dpp v46, v28, v10 row_newbcast:0 row_mask:0xf bank_mask:0xf
    v_and_b32_dpp v47, v28, v11 row_newbcast:0 row_mask:0xf bank_mask:0xf
    v_and_b32_dpp v48, v28, v8 row_newbcast:4 row_mask:0xf bank_mask:0xf
    v_and_b32_dpp v49, v28, v9 row_newbcast:4 row_mask:0xf bank_mask:0xf
    v_and_b32_dpp v50, v28, v10 row_newbcast:4 row_mask:0xf bank_mask:0xf
    v_and_b32_dpp v51, v28, v11 row_newbcast:4 row_mask:0xf bank_mask:0xf
    v_mfma_f32_16x16x32_bf16 v[16:19], v[44:47], v[132:135], v[16:19]
    s_add_u32 s16, s16, 0x2000
    s_cmp_lt_u32 s16, s27
    s_cbranch_scc1 L_v_a52
    s_mov_b32 s87, 13
    s_branch L_seg
L_v_a52:
    s_waitcnt vmcnt(9)
    buffer_load_dwordx4 v[132:135], v4, s[8:11], s16 offen nt
    v_and_b32_dpp v44, v28, v8 row_newbcast:8 row_mask:0xf bank_mask:0xf
    v_and_b32_dpp v45, v28, v9 row_newbcast:8 row_mask:0xf bank_mask:0xf
    v_and_b32_dpp v46, v28, v10 row_newbcast:8 row_mask:0xf bank_mask:0xf
    v_and_b32_dpp v47, v28, v11 row_newbcast:8 row_mask:0xf bank_mask:0xf
    v_mfma_f32_16x16x32_bf16 v[16:19], v[48:51], v[136:139], v[16:19]
    s_waitcnt lgkmcnt(0)
    v_sub_f32 v20, v21, v12
    ds_read_u16_d16_hi v21, v41 offset:32
    v_mul_f32 v20, s24, v20
    v_add_u32 v41, 32, v41
    v_exp_f32 v20, v20
    s_waitcnt vmcnt(10)
    buffer_load_dwordx4 v[136:139], v5, s[8:11], s16 offen nt
    v_and_b32_dpp v48, v28, v8 row_newbcast:12 row_mask:0xf bank_mask:0xf
    v_and_b32_dpp v49, v28, v9 row_newbcast:12 row_mask:0xf bank_mask:0xf
    v_and_b32_dpp v50, v28, v10 row_newbcast:12 row_mask:0xf bank_mask:0xf
    v_and_b32_dpp v51, v28, v11 row_newbcast:12 row_mask:0xf bank_mask:0xf
    v_mfma_f32_16x16x32_bf16 v[16:19], v[44:47], v[140:143], v[16:19]
    s_waitcnt vmcnt(10)
    buffer_load_dwordx4 v[140:143], v6, s[8:11], s16 offen nt
    v_mfma_f32_16x16x32_bf16 v[16:19], v[48:51], v[144:147], v[16:19]
    s_sub_u32 s23, s23, 1
    s_cmp_le_u32 s23, s77
    s_cbranch_scc1 L_rk_24
L_v_24:
    s_waitcnt vmcnt(10)
    buffer_load_dwordx4 v[144:147], v7, s[8:11], s16 offen nt
    v_cvt_pk_bf16_f32 v28, v20, v20
    v_add_f32 v13, v13, v20
    s_nop 0
    v_and_b32_dpp v44, v28, v8 row_newbcast:0 row_mask:0xf bank_mask:0xf
    v_and_b32_dpp v45, v28, v9 row_newbcast:0 row_mask:0xf bank_mask:0xf
    v_and_b32_dpp v46, v28, v10 row_newbcast:0 row_mask:0xf bank_mask:0xf
    v_and_b32_dpp v47, v28, v11 row_newbcast:0 row_mask:0xf bank_mask:0xf
    v_and_b32_dpp v48, v28, v8 row_newbcast:4 row_mask:0xf bank_mask:0xf
    v_and_b32_dpp v49, v28, v9 row_newbcast:4 row_mask:0xf bank_mask:0xf
    v_and_b32_dpp v50, v28, v10 row_newbcast:4 row_mask:0xf bank_mask:0xf
    v_and_b32_dpp v51, v28, v11 row_newbcast:4 row_mask:0xf bank_mask:0xf
    v_mfma_f32_16x16x32_bf16 v[16:19], v[44:47], v[148:151], v[16:19]
    s_add_u32 s16, s16, 0x2000
    s_cmp_lt_u32 s16, s27
    s_cbranch_scc1 L_v_a56
    s_mov_b32 s87, 14
    s_branch L_seg
L_v_a56:
    s_waitcnt vmcnt(9)
    buffer_load_dwordx4 v[148:151], v4, s[8:11], s16 offen nt
    v_and_b32_dpp v44, v28, v8 row_newbcast:8 row_mask:0xf bank_mask:0xf
    v_and_b32_dpp v45, v28, v9 row_newbcast:8 row_mask:0xf bank_mask:0xf
    v_and_b32_dpp v46, v28, v10 row_newbcast:8 row_mask:0xf bank_mask:0xf
    v_and_b32_dpp v47, v28, v11 row_newbcast:8 row_mask:0xf bank_mask:0xf
    v_mfma_f32_16x16x32_bf16 v[16:19], v[48:51], v[152:155], v[16:19]
    s_waitcnt lgkmcnt(0)
    v_sub_f32 v20, v21, v12
    ds_read_u16_d16_hi v21, v41 offset:32
    v_mul_f32 v20, s24, v20
    v_add_u32 v41, 32, v41
    v_exp_f32 v20, v20
    s_waitcnt vmcnt(10)
    buffer_load_dwordx4 v[152:155], v5, s[8:11], s16 offen nt
    v_and_b32_dpp v48, v28, v8 row_newbcast:12 row_mask:0xf bank_mask:0xf
    v_and_b32_dpp v49, v28, v9 row_newbcast:12 row_mask:0xf bank_mask:0xf
    v_and_b32_dpp v50, v28, v10 row_newbcast:12 row_mask:0xf bank_mask:0xf
    v_and_b32_dpp v51, v28, v11 row_newbcast:12 row_mask:0xf bank_mask:0xf
    v_mfma_f32_16x16x32_bf16 v[16:19], v[44:47], v[156:159], v[16:19]
    s_waitcnt vmcnt(10)
    buffer_load_dwordx4 v[156:159], v6, s[8:11], s16 offen nt
    v_mfma_f32_16x16x32_bf16 v[16:19], v[48:51], v[160:163], v[16:19]
    s_sub_u32 s23, s23, 1
    s_cmp_le_u32 s23, s77
    s_cbranch_scc1 L_rk_28
L_v_28:
    s_waitcnt vmcnt(10)
    buffer_load_dwordx4 v[160:163], v7, s[8:11], s16 offen nt
    v_cvt_pk_bf16_f32 v28, v20, v20
    v_add_f32 v13, v13, v20
    s_nop 0
    v_and_b32_dpp v44, v28, v8 row_newbcast:0 row_mask:0xf bank_mask:0xf
    v_and_b32_dpp v45, v28, v9 row_newbcast:0 row_mask:0xf bank_mask:0xf
    v_and_b32_dpp v46, v28, v10 row_newbcast:0 row_mask:0xf bank_mask:0xf
    v_and_b32_dpp v47, v28, v11 row_newbcast:0 row_mask:0xf bank_mask:0xf
    v_and_b32_dpp v48, v28, v8 row_newbcast:4 row_mask:0xf bank_mask:0xf
    v_and_b32_dpp v49, v28, v9 row_newbcast:4 row_mask:0xf bank_mask:0xf
    v_and_b32_dpp v50, v28, v10 row_newbcast:4 row_mask:0xf bank_mask:0xf
    v_and_b32_dpp v51, v28, v11 row_newbcast:4 row_mask:0xf bank_mask:0xf
    v_mfma_f32_16x16x32_bf16 v[16:19], v[44:47], v[164:167], v[16:19]
    s_add_u32 s16, s16, 0x2000
    s_cmp_lt_u32 s16, s27
    s_cbranch_scc1 L_v_a60
    s_mov_b32 s87, 15
    s_branch L_seg
L_v_a60:
    s_waitcnt vmcnt(9)
    buffer_load_dwordx4 v[164:167], v4, s[8:11], s16 offen nt
    v_and_b32_dpp v44, v28, v8 row_newbcast:8 row_mask:0xf bank_mask:0xf
    v_and_b32_dpp v45, v28, v9 row_newbcast:8 row_mask:0xf bank_mask:0xf
    v_and_b32_dpp v46, v28, v10 row_newbcast:8 row_mask:0xf bank_mask:0xf
    v_and_b32_dpp v47, v28, v11 row_newbcast:8 row_mask:0xf bank_mask:0xf
    v_mfma_f32_16x16x32_bf16 v[16:19], v[48:51], v[168:171], v[16:19]
    s_waitcnt lgkmcnt(0)
    v_sub_f32 v20, v21, v12
    ds_read_u16_d16_hi v21, v41 offset:32
    v_mul_f32 v20, s24, v20
    v_add_u32 v41, 32, v41
    v_exp_f32 v20, v20
    s_waitcnt vmcnt(10)
    buffer_load_dwordx4 v[168:171], v5, s[8:11], s16 offen nt
    v_and_b32_dpp v48, v28, v8 row_newbcast:12 row_mask:0xf bank_mask:0xf
    v_and_b32_dpp v49, v28, v9 row_newbcast:12 row_mask:0xf bank_mask:0xf
    v_and_b32_dpp v50, v28, v10 row_newbcast:12 row_mask:0xf bank_mask:0xf
    v_and_b32_dpp v51, v28, v11 row_newbcast:12 row_mask:0xf bank_mask:0xf
    v_mfma_f32_16x16x32_bf16 v[16:19], v[44:47], v[172:175], v[16:19]
    s_waitcnt vmcnt(10)
    buffer_load_dwordx4 v[172:175], v6, s[8:11], s16 offen nt
    v_mfma_f32_16x16x32_bf16 v[16:19], v[48:51], v[176:179], v[16:19]
    s_sub_u32 s23, s23, 1
    s_cmp_le_u32 s23, s77
    s_cbranch_scc1 L_rk_0
    s_branch L_v
L_rk_0:
    s_cmp_eq_u32 s76, 4
    s_cbranch_scc1 L_last_0
    s_mov_b32 s19, 0
    s_branch L_rk
L_rk_4:
    s_cmp_eq_u32 s76, 4
    s_cbranch_scc1 L_last_4
    s_mov_b32 s19, 4
    s_branch L_rk
L_rk_8:
    s_cmp_eq_u32 s76, 4
    s_cbranch_scc1 L_last_8
    s_mov_b32 s19, 8
    s_branch L_rk
L_rk_12:
    s_cmp_eq_u32 s76, 4
    s_cbranch_scc1 L_last_12
    s_mov_b32 s19, 12
    s_branch L_rk
L_rk_16:
    s_cmp_eq_u32 s76, 4
    s_cbranch_scc1 L_last_16
    s_mov_b32 s19, 16
    s_branch L_rk
L_rk_20:
    s_cmp_eq_u32 s76, 4
    s_cbranch_scc1 L_last_20
    s_mov_b32 s19, 20
    s_branch L_rk
L_rk_24:
    s_cmp_eq_u32 s76, 4
    s_cbranch_scc1 L_last_24
    s_mov_b32 s19, 24
    s_branch L_rk
L_rk_28:
    s_cmp_eq_u32 s76, 4
    s_cbranch_scc1 L_last_28
    s_mov_b32 s19, 28
L_rk:
    v_mov_b32 v24, 1472
    s_add_u32 s76, s76, 1
    s_bitcmp1_b32 s76, 0
    s_cbranch_scc0 L_rk1
    v_mov_b32 v25, s76
    ds_max_u32 v24, v25
    s_sub_u32 s77, s23, 4
    s_branch L_rkb
L_rk1:
    ds_read_b64 v[26:27], v24 offset:8
    s_waitcnt lgkmcnt(0)
    v_readfirstlane_b32 s75, v27
    s_sub_u32 s77, s23, 1
    s_cmp_le_u32 s23, 9
    s_cselect_b32 s75, s77, s75
    s_cmp_eq_u32 s75, 0
    s_cbranch_scc1 L_rkw
    s_min_u32 s77, s77, s75
    s_branch L_rkb
L_rkw:
    s_sub_u32 s76, s76, 1
L_rkb:
    s_cmp_eq_u32 s19, 4
    s_cbranch_scc1 L_v_4
    s_cmp_eq_u32 s19, 8
    s_cbranch_scc1 L_v_8
    s_cmp_eq_u32 s19, 12
    s_cbranch_scc1 L_v_12
    s_cmp_eq_u32 s19, 16
    s_cbranch_scc1 L_v_16
    s_cmp_eq_u32 s19, 20
    s_cbranch_scc1 L_v_20
    s_cmp_eq_u32 s19, 24
    s_cbranch_scc1 L_v_24
    s_cmp_eq_u32 s19, 28
    s_cbranch_scc1 L_v_28
    s_branch L_v_0
L_last:
L_last_0:
    s_waitcnt vmcnt(30)
    buffer_load_dwordx4 v[176:179], v7, s[8:11], s16 offen nt
    v_cvt_pk_bf16_f32 v28, v20, v20
    v_add_f32 v13, v13, v20
    s_nop 0
    v_and_b32_dpp v44, v28, v8 row_newbcast:0 row_mask:0xf bank_mask:0xf
    v_and_b32_dpp v45, v28, v9 row_newbcast:0 row_mask:0xf bank_mask:0xf
    v_and_b32_dpp v46, v28, v10 row_newbcast:0 row_mask:0xf bank_mask:0xf
    v_and_b32_dpp v47, v28, v11 row_newbcast:0 row_mask:0xf bank_mask:0xf
    v_and_b32_dpp v48, v28, v8 row_newbcast:4 row_mask:0xf bank_mask:0xf
    v_and_b32_dpp v49, v28, v9 row_newbcast:4 row_mask:0xf bank_mask:0xf
    v_and_b32_dpp v50, v28, v10 row_newbcast:4 row_mask:0xf bank_mask:0xf
    v_and_b32_dpp v51, v28, v11 row_newbcast:4 row_mask:0xf bank_mask:0xf
    v_mfma_f32_16x16x32_bf16 v[16:19], v[44:47], v[52:55], v[16:19]
    s_add_u32 s16, s16, 0x2000
    s_cmp_lt_u32 s16, s27
    s_cbranch_scc1 L_last_a32
    s_mov_b32 s87, 16
    s_branch L_seg
L_last_a32:
    s_waitcnt vmcnt(30)
    buffer_load_dwordx4 v[52:55], v4, s[8:11], s16 offen nt
    v_and_b32_dpp v44, v28, v8 row_newbcast:8 row_mask:0xf bank_mask:0xf
    v_and_b32_dpp v45, v28, v9 row_newbcast:8 row_mask:0xf bank_mask:0xf
    v_and_b32_dpp v46, v28, v10 row_newbcast:8 row_mask:0xf bank_mask:0xf
    v_and_b32_dpp v47, v28, v11 row_newbcast:8 row_mask:0xf bank_mask:0xf
    v_mfma_f32_16x16x32_bf16 v[16:19], v[48:51], v[56:59], v[16:19]
    s_waitcnt lgkmcnt(0)
    v_sub_f32 v20, v21, v12
    ds_read_u16_d16_hi v21, v41 offset:32
    v_mul_f32 v20, s24, v20
    v_add_u32 v41, 32, v41
    v_exp_f32 v20, v20
    s_waitcnt vmcnt(30)
    buffer_load_dwordx4 v[56:59], v5, s[8:11], s16 offen nt
    v_and_b32_dpp v48, v28, v8 row_newbcast:12 row_mask:0xf bank_mask:0xf
    v_and_b32_dpp v49, v28, v9 row_newbcast:12 row_mask:0xf bank_mask:0xf
    v_and_b32_dpp v50, v28, v10 row_newbcast:12 row_mask:0xf bank_mask:0xf
    v_and_b32_dpp v51, v28, v11 row_newbcast:12 row_mask:0xf bank_mask:0xf
    v_mfma_f32_16x16x32_bf16 v[16:19], v[44:47], v[60:63], v[16:19]
    s_waitcnt vmcnt(30)
    buffer_load_dwordx4 v[60:63], v6, s[8:11], s16 offen nt
    v_mfma_f32_16x16x32_bf16 v[16:19], v[48:51], v[64:67], v[16:19]
    s_sub_u32 s23, s23, 1
    s_cmp_eq_u32 s23, 0
    s_cbranch_scc1 L_done
L_last_4:
    s_waitcnt vmcnt(30)
    buffer_load_dwordx4 v[64:67], v7, s[8:11], s16 offen nt
    v_cvt_pk_bf16_f32 v28, v20, v20
    v_add_f32 v13, v13, v20
    s_nop 0
    v_and_b32_dpp v44, v28, v8 row_newbcast:0 row_mask:0xf bank_mask:0xf
    v_and_b32_dpp v45, v28, v9 row_newbcast:0 row_mask:0xf bank_mask:0xf
    v_and_b32_dpp v46, v28, v10 row_newbcast:0 row_mask:0xf bank_mask:0xf
    v_and_b32_dpp v47, v28, v11 row_newbcast:0 row_mask:0xf bank_mask:0xf
    v_and_b32_dpp v48, v28, v8 row_newbcast:4 row_mask:0xf bank_mask:0xf
    v_and_b32_dpp v49, v28, v9 row_newbcast:4 row_mask:0xf bank_mask:0xf
    v_and_b32_dpp v50, v28, v10 row_newbcast:4 row_mask:0xf bank_mask:0xf
    v_and_b32_dpp v51, v28, v11 row_newbcast:4 row_mask:0xf bank_mask:0xf
    v_mfma_f32_16x16x32_bf16 v[16:19], v[44:47], v[68:71], v[16:19]
    s_add_u32 s16, s16, 0x2000
    s_cmp_lt_u32 s16, s27
    s_cbranch_scc1 L_last_a36
    s_mov_b32 s87, 17
    s_branch L_seg
L_last_a36:
    s_waitcnt vmcnt(30)
    buffer_load_dwordx4 v[68:71], v4, s[8:11], s16 offen nt
    v_and_b32_dpp v44, v28, v8 row_newbcast:8 row_mask:0xf bank_mask:0xf
    v_and_b32_dpp v45, v28, v9 row_newbcast:8 row_mask:0xf bank_mask:0xf
    v_and_b32_dpp v46, v28, v10 row_newbcast:8 row_mask:0xf bank_mask:0xf
    v_and_b32_dpp v47, v28, v11 row_newbcast:8 row_mask:0xf bank_mask:0xf
    v_mfma_f32_16x16x32_bf16 v[16:19], v[48:51], v[72:75], v[16:19]
    s_waitcnt lgkmcnt(0)
    v_sub_f32 v20, v21, v12
    ds_read_u16_d16_hi v21, v41 offset:32
    v_mul_f32 v20, s24, v20
    v_add_u32 v41, 32, v41
    v_exp_f32 v20, v20
    s_waitcnt vmcnt(30)
    buffer_load_dwordx4 v[72:75], v5, s[8:11], s16 offen nt
    v_and_b32_dpp v48, v28, v8 row_newbcast:12 row_mask:0xf bank_mask:0xf
    v_and_b32_dpp v49, v28, v9 row_newbcast:12 row_mask:0xf bank_mask:0xf
    v_and_b32_dpp v50, v28, v10 row_newbcast:12 row_mask:0xf bank_mask:0xf
    v_and_b32_dpp v51, v28, v11 row_newbcast:12 row_mask:0xf bank_mask:0xf
    v_mfma_f32_16x16x32_bf16 v[16:19], v[44:47], v[76:79], v[16:19]
    s_waitcnt vmcnt(30)
    buffer_load_dwordx4 v[76:79], v6, s[8:11], s16 offen nt
    v_mfma_f32_16x16x32_bf16 v[16:19], v[48:51], v[80:83], v[16:19]
    s_sub_u32 s23, s23, 1
    s_cmp_eq_u32 s23, 0
    s_cbranch_scc1 L_done
L_last_8:
    s_waitcnt vmcnt(30)
    buffer_load_dwordx4 v[80:83], v7, s[8:11], s16 offen nt
    v_cvt_pk_bf16_f32 v28, v20, v20
    v_add_f32 v13, v13, v20
    s_nop 0
    v_and_b32_dpp v44, v28, v8 row_newbcast:0 row_mask:0xf bank_mask:0xf
    v_and_b32_dpp v45, v28, v9 row_newbcast:0 row_mask:0xf bank_mask:0xf
    v_and_b32_dpp v46, v28, v10 row_newbcast:0 row_mask:0xf bank_mask:0xf
    v_and_b32_dpp v47, v28, v11 row_newbcast:0 row_mask:0xf bank_mask:0xf
    v_and_b32_dpp v48, v28, v8 row_newbcast:4 row_mask:0xf bank_mask:0xf
    v_and_b32_dpp v49, v28, v9 row_newbcast:4 row_mask:0xf bank_mask:0xf
    v_and_b32_dpp v50, v28, v10 row_newbcast:4 row_mask:0xf bank_mask:0xf
    v_and_b32_dpp v51, v28, v11 row_newbcast:4 row_mask:0xf bank_mask:0xf
    v_mfma_f32_16x16x32_bf16 v[16:19], v[44:47], v[84:87], v[16:19]
    s_add_u32 s16, s16, 0x2000
    s_cmp_lt_u32 s16, s27
    s_cbranch_scc1 L_last_a40
    s_mov_b32 s87, 18
    s_branch L_seg
L_last_a40:
    s_waitcnt vmcnt(30)
    buffer_load_dwordx4 v[84:87], v4, s[8:11], s16 offen nt
    v_and_b32_dpp v44, v28, v8 row_newbcast:8 row_mask:0xf bank_mask:0xf
    v_and_b32_dpp v45, v28, v9 row_newbcast:8 row_mask:0xf bank_mask:0xf
    v_and_b32_dpp v46, v28, v10 row_newbcast:8 row_mask:0xf bank_mask:0xf
    v_and_b32_dpp v47, v28, v11 row_newbcast:8 row_mask:0xf bank_mask:0xf
    v_mfma_f32_16x16x32_bf16 v[16:19], v[48:51], v[88:91], v[16:19]
    s_waitcnt lgkmcnt(0)
    v_sub_f32 v20, v21, v12
    ds_read_u16_d16_hi v21, v41 offset:32
    v_mul_f32 v20, s24, v20
    v_add_u32 v41, 32, v41
    v_exp_f32 v20, v20
    s_waitcnt vmcnt(30)
    buffer_load_dwordx4 v[88:91], v5, s[8:11], s16 offen nt
    v_and_b32_dpp v48, v28, v8 row_newbcast:12 row_mask:0xf bank_mask:0xf
    v_and_b32_dpp v49, v28, v9 row_newbcast:12 row_mask:0xf bank_mask:0xf
    v_and_b32_dpp v50, v28, v10 row_newbcast:12 row_mask:0xf bank_mask:0xf
    v_and_b32_dpp v51, v28, v11 row_newbcast:12 row_mask:0xf bank_mask:0xf
    v_mfma_f32_16x16x32_bf16 v[16:19], v[44:47], v[92:95], v[16:19]
    s_waitcnt vmcnt(30)
    buffer_load_dwordx4 v[92:95], v6, s[8:11], s16 offen nt
    v_mfma_f32_16x16x32_bf16 v[16:19], v[48:51], v[96:99], v[16:19]
    s_sub_u32 s23, s23, 1
    s_cmp_eq_u32 s23, 0
    s_cbranch_scc1 L_done
L_last_12:
    s_waitcnt vmcnt(30)
    buffer_load_dwordx4 v[96:99], v7, s[8:11], s16 offen nt
    v_cvt_pk_bf16_f32 v28, v20, v20
    v_add_f32 v13, v13, v20
    s_nop 0
    v_and_b32_dpp v44, v28, v8 row_newbcast:0 row_mask:0xf bank_mask:0xf
    v_and_b32_dpp v45, v28, v9 row_newbcast:0 row_mask:0xf bank_mask:0xf
    v_and_b32_dpp v46, v28, v10 row_newbcast:0 row_mask:0xf bank_mask:0xf
    v_and_b32_dpp v47, v28, v11 row_newbcast:0 row_mask:0xf bank_mask:0xf
    v_and_b32_dpp v48, v28, v8 row_newbcast:4 row_mask:0xf bank_mask:0xf
    v_and_b32_dpp v49, v28, v9 row_newbcast:4 row_mask:0xf bank_mask:0xf
    v_and_b32_dpp v50, v28, v10 row_newbcast:4 row_mask:0xf bank_mask:0xf
    v_and_b32_dpp v51, v28, v11 row_newbcast:4 row_mask:0xf bank_mask:0xf
    v_mfma_f32_16x16x32_bf16 v[16:19], v[44:47], v[100:103], v[16:19]
    s_add_u32 s16, s16, 0x2000
    s_cmp_lt_u32 s16, s27
    s_cbranch_scc1 L_last_a44
    s_mov_b32 s87, 19
    s_branch L_seg
L_last_a44:
    s_waitcnt vmcnt(30)
    buffer_load_dwordx4 v[100:103], v4, s[8:11], s16 offen nt
    v_and_b32_dpp v44, v28, v8 row_newbcast:8 row_mask:0xf bank_mask:0xf
    v_and_b32_dpp v45, v28, v9 row_newbcast:8 row_mask:0xf bank_mask:0xf
    v_and_b32_dpp v46, v28, v10 row_newbcast:8 row_mask:0xf bank_mask:0xf
    v_and_b32_dpp v47, v28, v11 row_newbcast:8 row_mask:0xf bank_mask:0xf
    v_mfma_f32_16x16x32_bf16 v[16:19], v[48:51], v[104:107], v[16:19]
    s_waitcnt lgkmcnt(0)
    v_sub_f32 v20, v21, v12
    ds_read_u16_d16_hi v21, v41 offset:32
    v_mul_f32 v20, s24, v20
    v_add_u32 v41, 32, v41
    v_exp_f32 v20, v20
    s_waitcnt vmcnt(30)
    buffer_load_dwordx4 v[104:107], v5, s[8:11], s16 offen nt
    v_and_b32_dpp v48, v28, v8 row_newbcast:12 row_mask:0xf bank_mask:0xf
    v_and_b32_dpp v49, v28, v9 row_newbcast:12 row_mask:0xf bank_mask:0xf
    v_and_b32_dpp v50, v28, v10 row_newbcast:12 row_mask:0xf bank_mask:0xf
    v_and_b32_dpp v51, v28, v11 row_newbcast:12 row_mask:0xf bank_mask:0xf
    v_mfma_f32_16x16x32_bf16 v[16:19], v[44:47], v[108:111], v[16:19]
    s_waitcnt vmcnt(30)
    buffer_load_dwordx4 v[108:111], v6, s[8:11], s16 offen nt
    v_mfma_f32_16x16x32_bf16 v[16:19], v[48:51], v[112:115], v[16:19]
    s_sub_u32 s23, s23, 1
    s_cmp_eq_u32 s23, 0
    s_cbranch_scc1 L_done
L_last_16:
    s_waitcnt vmcnt(30)
    buffer_load_dwordx4 v[112:115], v7, s[8:11], s16 offen nt
    v_cvt_pk_bf16_f32 v28, v20, v20
    v_add_f32 v13, v13, v20
    s_nop 0
    v_and_b32_dpp v44, v28, v8 row_newbcast:0 row_mask:0xf bank_mask:0xf
    v_and_b32_dpp v45, v28, v9 row_newbcast:0 row_mask:0xf bank_mask:0xf
    v_and_b32_dpp v46, v28, v10 row_newbcast:0 row_mask:0xf bank_mask:0xf
    v_and_b32_dpp v47, v28, v11 row_newbcast:0 row_mask:0xf bank_mask:0xf
    v_and_b32_dpp v48, v28, v8 row_newbcast:4 row_mask:0xf bank_mask:0xf
    v_and_b32_dpp v49, v28, v9 row_newbcast:4 row_mask:0xf bank_mask:0xf
    v_and_b32_dpp v50, v28, v10 row_newbcast:4 row_mask:0xf bank_mask:0xf
    v_and_b32_dpp v51, v28, v11 row_newbcast:4 row_mask:0xf bank_mask:0xf
    v_mfma_f32_16x16x32_bf16 v[16:19], v[44:47], v[116:119], v[16:19]
    s_add_u32 s16, s16, 0x2000
    s_cmp_lt_u32 s16, s27
    s_cbranch_scc1 L_last_a48
    s_mov_b32 s87, 20
    s_branch L_seg
L_last_a48:
    s_waitcnt vmcnt(30)
    buffer_load_dwordx4 v[116:119], v4, s[8:11], s16 offen nt
    v_and_b32_dpp v44, v28, v8 row_newbcast:8 row_mask:0xf bank_mask:0xf
    v_and_b32_dpp v45, v28, v9 row_newbcast:8 row_mask:0xf bank_mask:0xf
    v_and_b32_dpp v46, v28, v10 row_newbcast:8 row_mask:0xf bank_mask:0xf
    v_and_b32_dpp v47, v28, v11 row_newbcast:8 row_mask:0xf bank_mask:0xf
    v_mfma_f32_16x16x32_bf16 v[16:19], v[48:51], v[120:123], v[16:19]
    s_waitcnt lgkmcnt(0)
    v_sub_f32 v20, v21, v12
    ds_read_u16_d16_hi v21, v41 offset:32
    v_mul_f32 v20, s24, v20
    v_add_u32 v41, 32, v41
    v_exp_f32 v20, v20
    s_waitcnt vmcnt(30)
    buffer_load_dwordx4 v[120:123], v5, s[8:11], s16 offen nt
    v_and_b32_dpp v48, v28, v8 row_newbcast:12 row_mask:0xf bank_mask:0xf
    v_and_b32_dpp v49, v28, v9 row_newbcast:12 row_mask:0xf bank_mask:0xf
    v_and_b32_dpp v50, v28, v10 row_newbcast:12 row_mask:0xf bank_mask:0xf
    v_and_b32_dpp v51, v28, v11 row_newbcast:12 row_mask:0xf bank_mask:0xf
    v_mfma_f32_16x16x32_bf16 v[16:19], v[44:47], v[124:127], v[16:19]
    s_waitcnt vmcnt(30)
    buffer_load_dwordx4 v[124:127], v6, s[8:11], s16 offen nt
    v_mfma_f32_16x16x32_bf16 v[16:19], v[48:51], v[128:131], v[16:19]
    s_sub_u32 s23, s23, 1
    s_cmp_eq_u32 s23, 0
    s_cbranch_scc1 L_done
L_last_20:
    s_waitcnt vmcnt(30)
    buffer_load_dwordx4 v[128:131], v7, s[8:11], s16 offen nt
    v_cvt_pk_bf16_f32 v28, v20, v20
    v_add_f32 v13, v13, v20
    s_nop 0
    v_and_b32_dpp v44, v28, v8 row_newbcast:0 row_mask:0xf bank_mask:0xf
    v_and_b32_dpp v45, v28, v9 row_newbcast:0 row_mask:0xf bank_mask:0xf
    v_and_b32_dpp v46, v28, v10 row_newbcast:0 row_mask:0xf bank_mask:0xf
    v_and_b32_dpp v47, v28, v11 row_newbcast:0 row_mask:0xf bank_mask:0xf
    v_and_b32_dpp v48, v28, v8 row_newbcast:4 row_mask:0xf bank_mask:0xf
    v_and_b32_dpp v49, v28, v9 row_newbcast:4 row_mask:0xf bank_mask:0xf
    v_and_b32_dpp v50, v28, v10 row_newbcast:4 row_mask:0xf bank_mask:0xf
    v_and_b32_dpp v51, v28, v11 row_newbcast:4 row_mask:0xf bank_mask:0xf
    v_mfma_f32_16x16x32_bf16 v[16:19], v[44:47], v[132:135], v[16:19]
    s_add_u32 s16, s16, 0x2000
    s_cmp_lt_u32 s16, s27
    s_cbranch_scc1 L_last_a52
    s_mov_b32 s87, 21
    s_branch L_seg
L_last_a52:
    s_waitcnt vmcnt(30)
    buffer_load_dwordx4 v[132:135], v4, s[8:11], s16 offen nt
    v_and_b32_dpp v44, v28, v8 row_newbcast:8 row_mask:0xf bank_mask:0xf
    v_and_b32_dpp v45, v28, v9 row_newbcast:8 row_mask:0xf bank_mask:0xf
    v_and_b32_dpp v46, v28, v10 row_newbcast:8 row_mask:0xf bank_mask:0xf
    v_and_b32_dpp v47, v28, v11 row_newbcast:8 row_mask:0xf bank_mask:0xf
    v_mfma_f32_16x16x32_bf16 v[16:19], v[48:51], v[136:139], v[16:19]
    s_waitcnt lgkmcnt(0)
    v_sub_f32 v20, v21, v12
    ds_read_u16_d16_hi v21, v41 offset:32
    v_mul_f32 v20, s24, v20
    v_add_u32 v41, 32, v41
    v_exp_f32 v20, v20
    s_waitcnt vmcnt(30)
    buffer_load_dwordx4 v[136:139], v5, s[8:11], s16 offen nt
    v_and_b32_dpp v48, v28, v8 row_newbcast:12 row_mask:0xf bank_mask:0xf
    v_and_b32_dpp v49, v28, v9 row_newbcast:12 row_mask:0xf bank_mask:0xf
    v_and_b32_dpp v50, v28, v10 row_newbcast:12 row_mask:0xf bank_mask:0xf
    v_and_b32_dpp v51, v28, v11 row_newbcast:12 row_mask:0xf bank_mask:0xf
    v_mfma_f32_16x16x32_bf16 v[16:19], v[44:47], v[140:143], v[16:19]
    s_waitcnt vmcnt(30)
    buffer_load_dwordx4 v[140:143], v6, s[8:11], s16 offen nt
    v_mfma_f32_16x16x32_bf16 v[16:19], v[48:51], v[144:147], v[16:19]
    s_sub_u32 s23, s23, 1
    s_cmp_eq_u32 s23, 0
    s_cbranch_scc1 L_done
L_last_24:
    s_waitcnt vmcnt(30)
    buffer_load_dwordx4 v[144:147], v7, s[8:11], s16 offen nt
    v_cvt_pk_bf16_f32 v28, v20, v20
    v_add_f32 v13, v13, v20
    s_nop 0
    v_and_b32_dpp v44, v28, v8 row_newbcast:0 row_mask:0xf bank_mask:0xf
    v_and_b32_dpp v45, v28, v9 row_newbcast:0 row_mask:0xf bank_mask:0xf
    v_and_b32_dpp v46, v28, v10 row_newbcast:0 row_mask:0xf bank_mask:0xf
    v_and_b32_dpp v47, v28, v11 row_newbcast:0 row_mask:0xf bank_mask:0xf
    v_and_b32_dpp v48, v28, v8 row_newbcast:4 row_mask:0xf bank_mask:0xf
    v_and_b32_dpp v49, v28, v9 row_newbcast:4 row_mask:0xf bank_mask:0xf
    v_and_b32_dpp v50, v28, v10 row_newbcast:4 row_mask:0xf bank_mask:0xf
    v_and_b32_dpp v51, v28, v11 row_newbcast:4 row_mask:0xf bank_mask:0xf
    v_mfma_f32_16x16x32_bf16 v[16:19], v[44:47], v[148:151], v[16:19]
    s_add_u32 s16, s16, 0x2000
    s_cmp_lt_u32 s16, s27
    s_cbranch_scc1 L_last_a56
    s_mov_b32 s87, 22
    s_branch L_seg
L_last_a56:
    s_waitcnt vmcnt(30)
    buffer_load_dwordx4 v[148:151], v4, s[8:11], s16 offen nt
    v_and_b32_dpp v44, v28, v8 row_newbcast:8 row_mask:0xf bank_mask:0xf
    v_and_b32_dpp v45, v28, v9 row_newbcast:8 row_mask:0xf bank_mask:0xf
    v_and_b32_dpp v46, v28, v10 row_newbcast:8 row_mask:0xf bank_mask:0xf
    v_and_b32_dpp v47, v28, v11 row_newbcast:8 row_mask:0xf bank_mask:0xf
    v_mfma_f32_16x16x32_bf16 v[16:19], v[48:51], v[152:155], v[16:19]
    s_waitcnt lgkmcnt(0)
    v_sub_f32 v20, v21, v12
    ds_read_u16_d16_hi v21, v41 offset:32
    v_mul_f32 v20, s24, v20
    v_add_u32 v41, 32, v41
    v_exp_f32 v20, v20
    s_waitcnt vmcnt(30)
    buffer_load_dwordx4 v[152:155], v5, s[8:11], s16 offen nt
    v_and_b32_dpp v48, v28, v8 row_newbcast:12 row_mask:0xf bank_mask:0xf
    v_and_b32_dpp v49, v28, v9 row_newbcast:12 row_mask:0xf bank_mask:0xf
    v_and_b32_dpp v50, v28, v10 row_newbcast:12 row_mask:0xf bank_mask:0xf
    v_and_b32_dpp v51, v28, v11 row_newbcast:12 row_mask:0xf bank_mask:0xf
    v_mfma_f32_16x16x32_bf16 v[16:19], v[44:47], v[156:159], v[16:19]
    s_waitcnt vmcnt(30)
    buffer_load_dwordx4 v[156:159], v6, s[8:11], s16 offen nt
    v_mfma_f32_16x16x32_bf16 v[16:19], v[48:51], v[160:163], v[16:19]
    s_sub_u32 s23, s23, 1
    s_cmp_eq_u32 s23, 0
    s_cbranch_scc1 L_done
L_last_28:
    s_waitcnt vmcnt(30)
    buffer_load_dwordx4 v[160:163], v7, s[8:11], s16 offen nt
    v_cvt_pk_bf16_f32 v28, v20, v20
    v_add_f32 v13, v13, v20
    s_nop 0
    v_and_b32_dpp v44, v28, v8 row_newbcast:0 row_mask:0xf bank_mask:0xf
    v_and_b32_dpp v45, v28, v9 row_newbcast:0 row_mask:0xf bank_mask:0xf
    v_and_b32_dpp v46, v28, v10 row_newbcast:0 row_mask:0xf bank_mask:0xf
    v_and_b32_dpp v47, v28, v11 row_newbcast:0 row_mask:0xf bank_mask:0xf
    v_and_b32_dpp v48, v28, v8 row_newbcast:4 row_mask:0xf bank_mask:0xf
    v_and_b32_dpp v49, v28, v9 row_newbcast:4 row_mask:0xf bank_mask:0xf
    v_and_b32_dpp v50, v28, v10 row_newbcast:4 row_mask:0xf bank_mask:0xf
    v_and_b32_dpp v51, v28, v11 row_newbcast:4 row_mask:0xf bank_mask:0xf
    v_mfma_f32_16x16x32_bf16 v[16:19], v[44:47], v[164:167], v[16:19]
    s_add_u32 s16, s16, 0x2000
    s_cmp_lt_u32 s16, s27
    s_cbranch_scc1 L_last_a60
    s_mov_b32 s87, 23
    s_branch L_seg
L_last_a60:
    s_waitcnt vmcnt(30)
    buffer_load_dwordx4 v[164:167], v4, s[8:11], s16 offen nt
    v_and_b32_dpp v44, v28, v8 row_newbcast:8 row_mask:0xf bank_mask:0xf
    v_and_b32_dpp v45, v28, v9 row_newbcast:8 row_mask:0xf bank_mask:0xf
    v_and_b32_dpp v46, v28, v10 row_newbcast:8 row_mask:0xf bank_mask:0xf
    v_and_b32_dpp v47, v28, v11 row_newbcast:8 row_mask:0xf bank_mask:0xf
    v_mfma_f32_16x16x32_bf16 v[16:19], v[48:51], v[168:171], v[16:19]
    s_waitcnt lgkmcnt(0)
    v_sub_f32 v20, v21, v12
    ds_read_u16_d16_hi v21, v41 offset:32
    v_mul_f32 v20, s24, v20
    v_add_u32 v41, 32, v41
    v_exp_f32 v20, v20
    s_waitcnt vmcnt(30)
    buffer_load_dwordx4 v[168:171], v5, s[8:11], s16 offen nt
    v_and_b32_dpp v48, v28, v8 row_newbcast:12 row_mask:0xf bank_mask:0xf
    v_and_b32_dpp v49, v28, v9 row_newbcast:12 row_mask:0xf bank_mask:0xf
    v_and_b32_dpp v50, v28, v10 row_newbcast:12 row_mask:0xf bank_mask:0xf
    v_and_b32_dpp v51, v28, v11 row_newbcast:12 row_mask:0xf bank_mask:0xf
    v_mfma_f32_16x16x32_bf16 v[16:19], v[44:47], v[172:175], v[16:19]
    s_waitcnt vmcnt(30)
    buffer_load_dwordx4 v[172:175], v6, s[8:11], s16 offen nt
    v_mfma_f32_16x16x32_bf16 v[16:19], v[48:51], v[176:179], v[16:19]
    s_sub_u32 s23, s23, 1
    s_cmp_eq_u32 s23, 0
    s_cbranch_scc1 L_done
    s_branch L_last
L_seg:
    s_cmp_eq_u32 s86, 1
    s_cbranch_scc0 L_seg2
    s_mov_b32 s86, 2
    s_mov_b32 s16, s14
    s_mov_b32 s27, s80
    s_cmp_lt_u32 s16, s27
    s_cbranch_scc1 L_segr
L_seg2:
    s_cmp_eq_u32 s86, 2
    s_cbranch_scc0 L_seg3
    s_mov_b32 s86, 3
    s_mov_b32 s16, s84
    s_mov_b32 s27, s85
    s_cmp_lt_u32 s16, s27
    s_cbranch_scc1 L_segr
L_seg3:
    s_cmp_eq_u32 s88, 0
    s_cbranch_scc0 L_seg4
    s_mov_b32 s88, 1
    s_mov_b32 s8, s40
    s_mov_b32 s9, s41
    s_mov_b32 s16, s80
    s_mov_b32 s27, s81
    s_mov_b32 s86, 1
    v_lshlrev_b32 v4, 4, v1
    v_add_u32 v5, 1024, v4
    v_add_u32 v6, 2048, v4
    v_add_u32 v7, 3072, v4
    s_branch L_segr
L_seg4:
    s_mov_b32 s10, 0
    s_mov_b32 s16, 0
    s_mov_b32 s27, -1
L_segr:
    s_cmp_lt_u32 s87, 12
    s_cbranch_scc0 L_tr12
    s_cmp_lt_u32 s87, 6
    s_cbranch_scc0 L_tr6
    s_cmp_lt_u32 s87, 3
    s_cbranch_scc0 L_tr3
    s_cmp_lt_u32 s87, 1
    s_cbranch_scc0 L_tr1
    s_branch L_k_a32
L_tr1:
    s_cmp_lt_u32 s87, 2
    s_cbranch_scc0 L_tr2
    s_branch L_k_a36
L_tr2:
    s_branch L_k_a40
L_tr3:
    s_cmp_lt_u32 s87, 4
    s_cbranch_scc0 L_tr4
    s_branch L_k_a44
L_tr4:
    s_cmp_lt_u32 s87, 5
    s_cbranch_scc0 L_tr5
    s_branch L_k_a48
L_tr5:
    s_branch L_k_a52
L_tr6:
    s_cmp_lt_u32 s87, 9
    s_cbranch_scc0 L_tr9
    s_cmp_lt_u32 s87, 7
    s_cbranch_scc0 L_tr7
    s_branch L_k_a56
L_tr7:
    s_cmp_lt_u32 s87, 8
    s_cbranch_scc0 L_tr8
    s_branch L_k_a60
L_tr8:
    s_branch L_v_a32
L_tr9:
    s_cmp_lt_u32 s87, 10
    s_cbranch_scc0 L_tr10
    s_branch L_v_a36
L_tr10:
    s_cmp_lt_u32 s87, 11
    s_cbranch_scc0 L_tr11
    s_branch L_v_a40
L_tr11:
    s_branch L_v_a44
L_tr12:
    s_cmp_lt_u32 s87, 18
    s_cbranch_scc0 L_tr18
    s_cmp_lt_u32 s87, 15
    s_cbranch_scc0 L_tr15
    s_cmp_lt_u32 s87, 13
    s_cbranch_scc0 L_tr13
    s_branch L_v_a48
L_tr13:
    s_cmp_lt_u32 s87, 14
    s_cbranch_scc0 L_tr14
    s_branch L_v_a52
L_tr14:
    s_branch L_v_a56
L_tr15:
    s_cmp_lt_u32 s87, 16
    s_cbranch_scc0 L_tr16
    s_branch L_v_a60
L_tr16:
    s_cmp_lt_u32 s87, 17
    s_cbranch_scc0 L_tr17
    s_branch L_last_a32
L_tr17:
    s_branch L_last_a36
L_tr18:
    s_cmp_lt_u32 s87, 21
    s_cbranch_scc0 L_tr21
    s_cmp_lt_u32 s87, 19
    s_cbranch_scc0 L_tr19
    s_branch L_last_a40
L_tr19:
    s_cmp_lt_u32 s87, 20
    s_cbranch_scc0 L_tr20
    s_branch L_last_a44
L_tr20:
    s_branch L_last_a48
L_tr21:
    s_cmp_lt_u32 s87, 22
    s_cbranch_scc0 L_tr22
    s_branch L_last_a52
L_tr22:
    s_cmp_lt_u32 s87, 23
    s_cbranch_scc0 L_tr23
    s_branch L_last_a56
L_tr23:
    s_branch L_last_a60
L_done:
    v_add_f32_dpp v13, v13, v13 row_ror:4 row_mask:0xf bank_mask:0xf
    s_nop 1
    v_add_f32_dpp v13, v13, v13 row_ror:8 row_mask:0xf bank_mask:0xf
    v_mov_b32 v28, v13
    s_nop 1
    v_permlane16_swap_b32 v28, v13
    v_add_f32 v13, v28, v13
    v_mov_b32 v28, v13
    s_nop 1
    v_permlane32_swap_b32 v28, v13
    v_add_f32 v13, v28, v13
    s_mov_b32 exec_hi, 0
    ds_write_b128 v14, v[16:19]
    ds_write_b64 v15, v[12:13] offset:512
    s_waitcnt lgkmcnt(0)
    s_cmp_eq_u32 s21, 7
    s_cbranch_scc1 L_sdone
    s_barrier
    s_endpgm
L_other:
    s_cmp_eq_u32 s21, 7
    s_cbranch_scc1 L_svc
    s_cmp_lg_u32 s3, 4
    s_cbranch_scc1 L_end
    s_setprio 3
    v_lshlrev_b32 v32, 2, v1
    v_lshlrev_b32 v12, 13, v3
    v_lshl_add_u32 v12, v2, 4, v12
    v_lshlrev_b32 v33, 3, v2
    v_lshl_add_u32 v33, v3, 1, v33
    v_mov_b32 v13, 0
    s_mul_i32 s18, s21, 144
    s_mul_i32 s19, s21, 589824
    s_lshl_b32 s16, s20, 8
    s_add_u32 s16, s16, s19
    s_lshl_b32 s33, s20, 12
    s_add_u32 s33, s33, 81920
    s_lshl_b32 s19, s21, 9
    s_add_u32 s19, s19, s33
    s_mov_b32 s17, 69632
    s_waitcnt lgkmcnt(0)
    s_mov_b32 s8, s36
    s_mov_b32 s9, s37
    s_mov_b32 s10, 0x480
    s_mov_b32 s11, 0x20000
    s_mov_b32 s12, s60
    s_mov_b32 s13, s61
    s_mov_b32 s14, 0x68000
    s_mov_b32 s15, 0x20000
    buffer_load_dword v4, v32, s[8:11], 0 offen offset:0
    buffer_load_dword v5, v32, s[8:11], 0 offen offset:256
    buffer_load_dword v6, v32, s[8:11], 0 offen offset:512
    buffer_load_dword v7, v32, s[8:11], 0 offen offset:768
    buffer_load_dword v8, v32, s[8:11], 0 offen offset:1024
    buffer_load_ushort v9, v33, s[8:11], s18 offen offset:0
    buffer_load_ushort v10, v33, s[8:11], s18 offen offset:128
    buffer_load_dword v11, v13, s[12:15], s17 offen sc1
    s_mov_b32 s12, s42
    s_mov_b32 s13, s43
    s_mov_b32 s14, 0x480000
    s_mov_b32 s15, 0x20000
    buffer_load_dwordx4 v[64:67], v12, s[12:15], s16 offen nt
    s_add_u32 s16, s16, 0x8000
    buffer_load_dwordx4 v[68:71], v12, s[12:15], s16 offen nt
    s_add_u32 s16, s16, 0x8000
    buffer_load_dwordx4 v[72:75], v12, s[12:15], s16 offen nt
    s_add_u32 s16, s16, 0x8000
    buffer_load_dwordx4 v[76:79], v12, s[12:15], s16 offen nt
    s_add_u32 s16, s16, 0x8000
    buffer_load_dwordx4 v[80:83], v12, s[12:15], s16 offen nt
    s_add_u32 s16, s16, 0x8000
    buffer_load_dwordx4 v[84:87], v12, s[12:15], s16 offen nt
    s_add_u32 s16, s16, 0x8000
    buffer_load_dwordx4 v[88:91], v12, s[12:15], s16 offen nt
    s_add_u32 s16, s16, 0x8000
    buffer_load_dwordx4 v[92:95], v12, s[12:15], s16 offen nt
    s_add_u32 s16, s16, 0x8000
    buffer_load_dwordx4 v[96:99], v12, s[12:15], s16 offen nt
    s_add_u32 s16, s16, 0x8000
    buffer_load_dwordx4 v[100:103], v12, s[12:15], s16 offen nt
    s_add_u32 s16, s16, 0x8000
    buffer_load_dwordx4 v[104:107], v12, s[12:15], s16 offen nt
    s_add_u32 s16, s16, 0x8000
    buffer_load_dwordx4 v[108:111], v12, s[12:15], s16 offen nt
    s_add_u32 s16, s16, 0x8000
    buffer_load_dwordx4 v[112:115], v12, s[12:15], s16 offen nt
    s_add_u32 s16, s16, 0x8000
    buffer_load_dwordx4 v[116:119], v12, s[12:15], s16 offen nt
    s_add_u32 s16, s16, 0x8000
    buffer_load_dwordx4 v[120:123], v12, s[12:15], s16 offen nt
    s_add_u32 s16, s16, 0x8000
    buffer_load_dwordx4 v[124:127], v12, s[12:15], s16 offen nt
    s_add_u32 s16, s16, 0x8000
    buffer_load_dwordx4 v[128:131], v12, s[12:15], s16 offen nt
    s_add_u32 s16, s16, 0x8000
    buffer_load_dwordx4 v[132:135], v12, s[12:15], s16 offen nt
    s_barrier
    s_mov_b32 s8, s60
    s_mov_b32 s9, s61
    s_mov_b32 s10, 0x68000
    s_mov_b32 s11, 0x20000
    v_and_b32 v34, 1, v2
    v_cmp_eq_u32 vcc, 0, v34
    v_mov_b32 v35, 0xffff0000
    v_mov_b32 v36, 0xffff
    v_cndmask_b32 v34, v35, v36, vcc
    v_lshrrev_b32 v35, 1, v2
    v_cmp_eq_u32 vcc, 0, v35
    s_nop 1
    v_cndmask_b32 v14, 0, v34, vcc
    v_cmp_eq_u32 vcc, 1, v35
    s_nop 1
    v_cndmask_b32 v15, 0, v34, vcc
    v_cmp_eq_u32 vcc, 2, v35
    s_nop 1
    v_cndmask_b32 v16, 0, v34, vcc
    v_cmp_eq_u32 vcc, 3, v35
    s_nop 1
    v_cndmask_b32 v17, 0, v34, vcc
    v_and_b32 v32, 1, v3
    v_lshlrev_b32 v32, 1, v32
    v_lshl_add_u32 v32, v2, 2, v32
    v_lshrrev_b32 v33, 1, v3
    v_add_lshl_u32 v13, v32, v33, 3
    s_waitcnt vmcnt(21)
    v_lshlrev_b32 v36, 16, v4
    v_and_b32 v37, 0xffff0000, v4
    v_lshlrev_b32 v38, 16, v5
    v_and_b32 v39, 0xffff0000, v5
    v_lshlrev_b32 v40, 16, v6
    v_and_b32 v41, 0xffff0000, v6
    v_lshlrev_b32 v42, 16, v7
    v_and_b32 v43, 0xffff0000, v7
    v_lshlrev_b32 v44, 16, v8
    v_and_b32 v45, 0xffff0000, v8
    v_add_f32 v46, v36, v37
    v_add_f32 v46, v46, v38
    v_add_f32 v46, v46, v39
    v_add_f32 v46, v46, v40
    v_add_f32 v46, v46, v41
    v_add_f32 v46, v46, v42
    v_add_f32 v46, v46, v43
    v_add_f32 v46, v46, v44
    v_add_f32 v46, v46, v45
    s_nop 1
    v_add_f32_dpp v46, v46, v46 row_ror:8 row_mask:0xf bank_mask:0xf
    s_nop 1
    v_add_f32_dpp v46, v46, v46 row_ror:4 row_mask:0xf bank_mask:0xf
    s_nop 1
    v_add_f32_dpp v46, v46, v46 row_ror:2 row_mask:0xf bank_mask:0xf
    s_nop 1
    v_add_f32_dpp v46, v46, v46 row_ror:1 row_mask:0xf bank_mask:0xf
    v_mov_b32 v47, v46
    s_nop 1
    v_permlane16_swap_b32 v47, v46
    v_add_f32 v46, v47, v46
    v_mov_b32 v47, v46
    s_nop 1
    v_permlane32_swap_b32 v47, v46
    v_add_f32 v46, v47, v46
    v_mul_f32 v46, 0x3ae38e39, v46
    v_sub_f32 v36, v36, v46
    v_sub_f32 v37, v37, v46
    v_sub_f32 v38, v38, v46
    v_sub_f32 v39, v39, v46
    v_sub_f32 v40, v40, v46
    v_sub_f32 v41, v41, v46
    v_sub_f32 v42, v42, v46
    v_sub_f32 v43, v43, v46
    v_sub_f32 v44, v44, v46
    v_sub_f32 v45, v45, v46
    v_cmp_gt_u32 vcc, 32, v1
    s_nop 1
    v_cndmask_b32 v44, 0, v44, vcc
    v_cndmask_b32 v45, 0, v45, vcc
    v_mul_f32 v48, v36, v36
    v_fmac_f32 v48, v37, v37
    v_fmac_f32 v48, v38, v38
    v_fmac_f32 v48, v39, v39
    v_fmac_f32 v48, v40, v40
    v_fmac_f32 v48, v41, v41
    v_fmac_f32 v48, v42, v42
    v_fmac_f32 v48, v43, v43
    v_fmac_f32 v48, v44, v44
    v_fmac_f32 v48, v45, v45
    s_nop 1
    v_add_f32_dpp v48, v48, v48 row_ror:8 row_mask:0xf bank_mask:0xf
    s_nop 1
    v_add_f32_dpp v48, v48, v48 row_ror:4 row_mask:0xf bank_mask:0xf
    s_nop 1
    v_add_f32_dpp v48, v48, v48 row_ror:2 row_mask:0xf bank_mask:0xf
    s_nop 1
    v_add_f32_dpp v48, v48, v48 row_ror:1 row_mask:0xf bank_mask:0xf
    v_mov_b32 v47, v48
    s_nop 1
    v_permlane16_swap_b32 v47, v48
    v_add_f32 v48, v47, v48
    v_mov_b32 v47, v48
    s_nop 1
    v_permlane32_swap_b32 v47, v48
    v_add_f32 v48, v47, v48
    v_mul_f32 v19, 0x3ae38e39, v48
    v_mov_b32 v18, v46
    v_cvt_pk_bf16_f32 v18, v18, v18
    v_and_b32 v18, 0xffff0000, v18
    v_cvt_pk_bf16_f32 v19, v19, v19
    v_and_b32 v19, 0xffff0000, v19
    v_add_f32 v19, 0x3727c5ac, v19
    v_cvt_pk_bf16_f32 v19, v19, v19
    v_and_b32 v19, 0xffff0000, v19
    v_sqrt_f32 v19, v19
    s_nop 0
    v_cvt_pk_bf16_f32 v19, v19, v19
    v_and_b32 v19, 0xffff0000, v19
    v_rcp_f32 v19, v19
    s_waitcnt vmcnt(18)
    v_lshlrev_b32 v9, 16, v9
    v_sub_f32 v9, v9, v18
    v_cvt_pk_bf16_f32 v9, v9, v9
    v_and_b32 v9, 0xffff0000, v9
    v_mul_f32 v9, v9, v19
    v_cvt_pk_bf16_f32 v9, v9, v9
    v_lshlrev_b32 v10, 16, v10
    v_sub_f32 v10, v10, v18
    v_cvt_pk_bf16_f32 v10, v10, v10
    v_and_b32 v10, 0xffff0000, v10
    v_mul_f32 v10, v10, v19
    v_cvt_pk_bf16_f32 v10, v10, v10
    s_mov_b32 s16, 1664525
    v_mul_lo_u32 v11, v11, s16
    v_add_u32 v11, 0x3c6ef35f, v11
    v_and_b32_dpp v24, v9, v14 row_newbcast:0 row_mask:0xf bank_mask:0xf
    v_and_b32_dpp v25, v9, v15 row_newbcast:0 row_mask:0xf bank_mask:0xf
    v_and_b32_dpp v26, v9, v16 row_newbcast:0 row_mask:0xf bank_mask:0xf
    v_and_b32_dpp v27, v9, v17 row_newbcast:0 row_mask:0xf bank_mask:0xf
    v_and_b32_dpp v28, v9, v14 row_newbcast:1 row_mask:0xf bank_mask:0xf
    v_and_b32_dpp v29, v9, v15 row_newbcast:1 row_mask:0xf bank_mask:0xf
    v_and_b32_dpp v30, v9, v16 row_newbcast:1 row_mask:0xf bank_mask:0xf
    v_and_b32_dpp v31, v9, v17 row_newbcast:1 row_mask:0xf bank_mask:0xf
    s_waitcnt vmcnt(17)
    v_mfma_f32_16x16x32_bf16 v[20:23], v[24:27], v[64:67], 0
    v_and_b32_dpp v24, v9, v14 row_newbcast:2 row_mask:0xf bank_mask:0xf
    v_and_b32_dpp v25, v9, v15 row_newbcast:2 row_mask:0xf bank_mask:0xf
    v_and_b32_dpp v26, v9, v16 row_newbcast:2 row_mask:0xf bank_mask:0xf
    v_and_b32_dpp v27, v9, v17 row_newbcast:2 row_mask:0xf bank_mask:0xf
    s_waitcnt vmcnt(16)
    v_mfma_f32_16x16x32_bf16 v[20:23], v[28:31], v[68:71], v[20:23]
    v_and_b32_dpp v28, v9, v14 row_newbcast:3 row_mask:0xf bank_mask:0xf
    v_and_b32_dpp v29, v9, v15 row_newbcast:3 row_mask:0xf bank_mask:0xf
    v_and_b32_dpp v30, v9, v16 row_newbcast:3 row_mask:0xf bank_mask:0xf
    v_and_b32_dpp v31, v9, v17 row_newbcast:3 row_mask:0xf bank_mask:0xf
    s_waitcnt vmcnt(15)
    v_mfma_f32_16x16x32_bf16 v[20:23], v[24:27], v[72:75], v[20:23]
    v_and_b32_dpp v24, v9, v14 row_newbcast:4 row_mask:0xf bank_mask:0xf
    v_and_b32_dpp v25, v9, v15 row_newbcast:4 row_mask:0xf bank_mask:0xf
    v_and_b32_dpp v26, v9, v16 row_newbcast:4 row_mask:0xf bank_mask:0xf
    v_and_b32_dpp v27, v9, v17 row_newbcast:4 row_mask:0xf bank_mask:0xf
    s_waitcnt vmcnt(14)
    v_mfma_f32_16x16x32_bf16 v[20:23], v[28:31], v[76:79], v[20:23]
    v_and_b32_dpp v28, v9, v14 row_newbcast:5 row_mask:0xf bank_mask:0xf
    v_and_b32_dpp v29, v9, v15 row_newbcast:5 row_mask:0xf bank_mask:0xf
    v_and_b32_dpp v30, v9, v16 row_newbcast:5 row_mask:0xf bank_mask:0xf
    v_and_b32_dpp v31, v9, v17 row_newbcast:5 row_mask:0xf bank_mask:0xf
    s_waitcnt vmcnt(13)
    v_mfma_f32_16x16x32_bf16 v[20:23], v[24:27], v[80:83], v[20:23]
    v_and_b32_dpp v24, v9, v14 row_newbcast:6 row_mask:0xf bank_mask:0xf
    v_and_b32_dpp v25, v9, v15 row_newbcast:6 row_mask:0xf bank_mask:0xf
    v_and_b32_dpp v26, v9, v16 row_newbcast:6 row_mask:0xf bank_mask:0xf
    v_and_b32_dpp v27, v9, v17 row_newbcast:6 row_mask:0xf bank_mask:0xf
    s_waitcnt vmcnt(12)
    v_mfma_f32_16x16x32_bf16 v[20:23], v[28:31], v[84:87], v[20:23]
    v_and_b32_dpp v28, v9, v14 row_newbcast:7 row_mask:0xf bank_mask:0xf
    v_and_b32_dpp v29, v9, v15 row_newbcast:7 row_mask:0xf bank_mask:0xf
    v_and_b32_dpp v30, v9, v16 row_newbcast:7 row_mask:0xf bank_mask:0xf
    v_and_b32_dpp v31, v9, v17 row_newbcast:7 row_mask:0xf bank_mask:0xf
    s_waitcnt vmcnt(11)
    v_mfma_f32_16x16x32_bf16 v[20:23], v[24:27], v[88:91], v[20:23]
    v_and_b32_dpp v24, v9, v14 row_newbcast:8 row_mask:0xf bank_mask:0xf
    v_and_b32_dpp v25, v9, v15 row_newbcast:8 row_mask:0xf bank_mask:0xf
    v_and_b32_dpp v26, v9, v16 row_newbcast:8 row_mask:0xf bank_mask:0xf
    v_and_b32_dpp v27, v9, v17 row_newbcast:8 row_mask:0xf bank_mask:0xf
    s_waitcnt vmcnt(10)
    v_mfma_f32_16x16x32_bf16 v[20:23], v[28:31], v[92:95], v[20:23]
    v_and_b32_dpp v28, v9, v14 row_newbcast:9 row_mask:0xf bank_mask:0xf
    v_and_b32_dpp v29, v9, v15 row_newbcast:9 row_mask:0xf bank_mask:0xf
    v_and_b32_dpp v30, v9, v16 row_newbcast:9 row_mask:0xf bank_mask:0xf
    v_and_b32_dpp v31, v9, v17 row_newbcast:9 row_mask:0xf bank_mask:0xf
    s_waitcnt vmcnt(9)
    v_mfma_f32_16x16x32_bf16 v[20:23], v[24:27], v[96:99], v[20:23]
    v_and_b32_dpp v24, v9, v14 row_newbcast:10 row_mask:0xf bank_mask:0xf
    v_and_b32_dpp v25, v9, v15 row_newbcast:10 row_mask:0xf bank_mask:0xf
    v_and_b32_dpp v26, v9, v16 row_newbcast:10 row_mask:0xf bank_mask:0xf
    v_and_b32_dpp v27, v9, v17 row_newbcast:10 row_mask:0xf bank_mask:0xf
    s_waitcnt vmcnt(8)
    v_mfma_f32_16x16x32_bf16 v[20:23], v[28:31], v[100:103], v[20:23]
    v_and_b32_dpp v28, v9, v14 row_newbcast:11 row_mask:0xf bank_mask:0xf
    v_and_b32_dpp v29, v9, v15 row_newbcast:11 row_mask:0xf bank_mask:0xf
    v_and_b32_dpp v30, v9, v16 row_newbcast:11 row_mask:0xf bank_mask:0xf
    v_and_b32_dpp v31, v9, v17 row_newbcast:11 row_mask:0xf bank_mask:0xf
    s_waitcnt vmcnt(7)
    v_mfma_f32_16x16x32_bf16 v[20:23], v[24:27], v[104:107], v[20:23]
    v_and_b32_dpp v24, v9, v14 row_newbcast:12 row_mask:0xf bank_mask:0xf
    v_and_b32_dpp v25, v9, v15 row_newbcast:12 row_mask:0xf bank_mask:0xf
    v_and_b32_dpp v26, v9, v16 row_newbcast:12 row_mask:0xf bank_mask:0xf
    v_and_b32_dpp v27, v9, v17 row_newbcast:12 row_mask:0xf bank_mask:0xf
    s_waitcnt vmcnt(6)
    v_mfma_f32_16x16x32_bf16 v[20:23], v[28:31], v[108:111], v[20:23]
    v_and_b32_dpp v28, v9, v14 row_newbcast:13 row_mask:0xf bank_mask:0xf
    v_and_b32_dpp v29, v9, v15 row_newbcast:13 row_mask:0xf bank_mask:0xf
    v_and_b32_dpp v30, v9, v16 row_newbcast:13 row_mask:0xf bank_mask:0xf
    v_and_b32_dpp v31, v9, v17 row_newbcast:13 row_mask:0xf bank_mask:0xf
    s_waitcnt vmcnt(5)
    v_mfma_f32_16x16x32_bf16 v[20:23], v[24:27], v[112:115], v[20:23]
    v_and_b32_dpp v24, v9, v14 row_newbcast:14 row_mask:0xf bank_mask:0xf
    v_and_b32_dpp v25, v9, v15 row_newbcast:14 row_mask:0xf bank_mask:0xf
    v_and_b32_dpp v26, v9, v16 row_newbcast:14 row_mask:0xf bank_mask:0xf
    v_and_b32_dpp v27, v9, v17 row_newbcast:14 row_mask:0xf bank_mask:0xf
    s_waitcnt vmcnt(4)
    v_mfma_f32_16x16x32_bf16 v[20:23], v[28:31], v[116:119], v[20:23]
    v_and_b32_dpp v28, v9, v14 row_newbcast:15 row_mask:0xf bank_mask:0xf
    v_and_b32_dpp v29, v9, v15 row_newbcast:15 row_mask:0xf bank_mask:0xf
    v_and_b32_dpp v30, v9, v16 row_newbcast:15 row_mask:0xf bank_mask:0xf
    v_and_b32_dpp v31, v9, v17 row_newbcast:15 row_mask:0xf bank_mask:0xf
    s_waitcnt vmcnt(3)
    v_mfma_f32_16x16x32_bf16 v[20:23], v[24:27], v[120:123], v[20:23]
    v_and_b32_dpp v24, v10, v14 row_newbcast:0 row_mask:0xf bank_mask:0xf
    v_and_b32_dpp v25, v10, v15 row_newbcast:0 row_mask:0xf bank_mask:0xf
    v_and_b32_dpp v26, v10, v16 row_newbcast:0 row_mask:0xf bank_mask:0xf
    v_and_b32_dpp v27, v10, v17 row_newbcast:0 row_mask:0xf bank_mask:0xf
    s_waitcnt vmcnt(2)
    v_mfma_f32_16x16x32_bf16 v[20:23], v[28:31], v[124:127], v[20:23]
    v_and_b32_dpp v28, v10, v14 row_newbcast:1 row_mask:0xf bank_mask:0xf
    v_and_b32_dpp v29, v10, v15 row_newbcast:1 row_mask:0xf bank_mask:0xf
    v_and_b32_dpp v30, v10, v16 row_newbcast:1 row_mask:0xf bank_mask:0xf
    v_and_b32_dpp v31, v10, v17 row_newbcast:1 row_mask:0xf bank_mask:0xf
    s_waitcnt vmcnt(1)
    v_mfma_f32_16x16x32_bf16 v[20:23], v[24:27], v[128:131], v[20:23]
    s_waitcnt vmcnt(0)
    v_mfma_f32_16x16x32_bf16 v[20:23], v[28:31], v[132:135], v[20:23]
    s_nop 7
    v_permlane32_swap_b32 v20, v22
    v_permlane32_swap_b32 v21, v23
    v_add_u32 v20, 8, v20
    v_bfi_b32 v20, 15, v11, v20
    v_add_u32 v21, 8, v21
    v_bfi_b32 v21, 15, v11, v21
    s_getreg_b32 s34, hwreg(HW_REG_XCC_ID, 0, 3)
    s_lshl_b32 s34, s34, 4
    v_mov_b32 v28, s34
    v_mov_b32 v29, 0x70
    s_mov_b64 exec, 1
    v_bfi_b32 v20, v29, v28, v20
    s_mov_b64 exec, -1
    buffer_store_dwordx2 v[20:21], v13, s[8:11], s19 offen sc1
    v_lshlrev_b32 v4, 3, v1
    s_mov_b32 s30, 65536
    s_waitcnt vmcnt(0)
L_qh:
    buffer_load_dwordx2 v[64:65], v4, s[8:11], s33 offen offset:0 sc1
    buffer_load_dwordx2 v[66:67], v4, s[8:11], s33 offen offset:512 sc1
    buffer_load_dwordx2 v[68:69], v4, s[8:11], s33 offen offset:1024 sc1
    buffer_load_dwordx2 v[70:71], v4, s[8:11], s33 offen offset:1536 sc1
    buffer_load_dwordx2 v[72:73], v4, s[8:11], s33 offen offset:2048 sc1
    buffer_load_dwordx2 v[74:75], v4, s[8:11], s33 offen offset:2560 sc1
    buffer_load_dwordx2 v[76:77], v4, s[8:11], s33 offen offset:3072 sc1
    buffer_load_dwordx2 v[78:79], v4, s[8:11], s33 offen offset:3584 sc1
    s_waitcnt vmcnt(0)
    v_xor_b32 v5, v64, v11
    v_xor_b32 v6, v65, v11
    v_xor_b32 v7, v66, v11
    v_xor_b32 v8, v67, v11
    v_or3_b32 v5, v5, v7, v8
    v_xor_b32 v7, v68, v11
    v_xor_b32 v8, v69, v11
    v_or3_b32 v5, v5, v7, v8
    v_xor_b32 v7, v70, v11
    v_xor_b32 v8, v71, v11
    v_or3_b32 v5, v5, v7, v8
    v_xor_b32 v7, v72, v11
    v_xor_b32 v8, v73, v11
    v_or3_b32 v5, v5, v7, v8
    v_xor_b32 v7, v74, v11
    v_xor_b32 v8, v75, v11
    v_or3_b32 v5, v5, v7, v8
    v_xor_b32 v7, v76, v11
    v_xor_b32 v8, v77, v11
    v_or3_b32 v5, v5, v7, v8
    v_xor_b32 v7, v78, v11
    v_xor_b32 v8, v79, v11
    v_or3_b32 v5, v5, v7, v8
    v_or_b32 v5, v5, v6
    v_and_b32 v5, 15, v5
    v_cmp_ne_u32 vcc, 0, v5
    s_nop 1
    s_cbranch_vccz L_qh_ok
    s_sub_u32 s30, s30, 1
    s_cmp_lg_u32 s30, 0
    s_cbranch_scc1 L_qh
L_qh_ok:
    v_lshl_add_u32 v9, v1, 2, s22
    v_mov_b32 v30, -16
    s_mov_b64 exec, 1
    v_mov_b32 v30, 0xffffff80
    s_mov_b64 exec, -1
    v_and_b32 v80, v30, v64
    v_and_b32 v81, -16, v65
    v_and_b32 v82, v30, v66
    v_and_b32 v83, -16, v67
    v_and_b32 v84, v30, v68
    v_and_b32 v85, -16, v69
    v_and_b32 v86, v30, v70
    v_and_b32 v87, -16, v71
    v_and_b32 v88, v30, v72
    v_and_b32 v89, -16, v73
    v_and_b32 v90, v30, v74
    v_and_b32 v91, -16, v75
    v_and_b32 v92, v30, v76
    v_and_b32 v93, -16, v77
    v_and_b32 v94, v30, v78
    v_and_b32 v95, -16, v79
    v_add_f32 v80, v80, v88
    v_add_f32 v81, v81, v89
    v_add_f32 v82, v82, v90
    v_add_f32 v83, v83, v91
    v_add_f32 v84, v84, v92
    v_add_f32 v85, v85, v93
    v_add_f32 v86, v86, v94
    v_add_f32 v87, v87, v95
    v_add_f32 v80, v80, v84
    v_add_f32 v81, v81, v85
    v_add_f32 v82, v82, v86
    v_add_f32 v83, v83, v87
    v_add_f32 v80, v80, v82
    v_add_f32 v81, v81, v83
    v_cvt_pk_bf16_f32 v5, v80, v81
    ds_write_b32 v9, v5 offset:0
    v_mov_b32 v4, 1472
    v_mov_b32 v6, 0
    v_mov_b32 v7, 0
    ds_write_b64 v4, v[6:7]
    ds_write_b64 v4, v[6:7] offset:8
    s_waitcnt lgkmcnt(0)
    s_barrier
    s_setprio 0
    v_xor_b32 v5, v64, v28
    v_xor_b32 v7, v66, v28
    v_or_b32 v5, v5, v7
    v_xor_b32 v7, v68, v28
    v_or_b32 v5, v5, v7
    v_xor_b32 v7, v70, v28
    v_or_b32 v5, v5, v7
    v_xor_b32 v7, v72, v28
    v_or_b32 v5, v5, v7
    v_xor_b32 v7, v74, v28
    v_or_b32 v5, v5, v7
    v_xor_b32 v7, v76, v28
    v_or_b32 v5, v5, v7
    v_xor_b32 v7, v78, v28
    v_or_b32 v5, v5, v7
    v_and_b32 v5, 0x70, v5
    s_nop 0
    v_readfirstlane_b32 s35, v5
    s_lshl_b32 s17, s21, 8
    s_add_u32 s17, s17, 360448
    s_add_u32 s4, s60, s17
    s_addc_u32 s5, s61, 0
    s_lshl_b32 s16, s20, 11
    s_add_u32 s16, s16, s17
    v_mov_b32 v7, 0
    v_readfirstlane_b32 s29, v11
    s_mov_b32 s30, 65536
L_ms3:
    ds_read_b32 v6, v4
    s_waitcnt lgkmcnt(0)
    v_cmp_gt_u32 vcc, 3, v6
    s_nop 1
    s_cbranch_vccz L_ms3_ok
    s_sub_u32 s30, s30, 1
    s_cmp_eq_u32 s30, 0
    s_cbranch_scc1 L_ms3_ok
    s_sleep 4
    s_branch L_ms3
L_ms3_ok:
    s_load_dword s62, s[4:5], 8 glc
    s_load_dword s63, s[4:5], 2056 glc
    s_load_dword s64, s[4:5], 4104 glc
    s_load_dword s65, s[4:5], 6152 glc
    s_load_dword s66, s[4:5], 8200 glc
    s_load_dword s67, s[4:5], 10248 glc
    s_load_dword s68, s[4:5], 12296 glc
    s_load_dword s69, s[4:5], 14344 glc
    s_load_dword s70, s[4:5], 16392 glc
    s_load_dword s71, s[4:5], 18440 glc
    s_load_dword s72, s[4:5], 20488 glc
    s_load_dword s73, s[4:5], 22536 glc
    s_load_dword s74, s[4:5], 24584 glc
    s_load_dword s75, s[4:5], 26632 glc
    s_load_dword s76, s[4:5], 28680 glc
    s_load_dword s77, s[4:5], 30728 glc
    s_load_dword s78, s[4:5], 32776 glc
    s_load_dword s79, s[4:5], 34824 glc
    s_load_dword s80, s[4:5], 36872 glc
    s_load_dword s81, s[4:5], 38920 glc
    s_load_dword s82, s[4:5], 40968 glc
    s_load_dword s83, s[4:5], 43016 glc
    s_load_dword s84, s[4:5], 45064 glc
    s_load_dword s85, s[4:5], 47112 glc
    s_load_dword s86, s[4:5], 49160 glc
    s_load_dword s87, s[4:5], 51208 glc
    s_load_dword s88, s[4:5], 53256 glc
    s_load_dword s89, s[4:5], 55304 glc
    s_load_dword s90, s[4:5], 57352 glc
    s_load_dword s91, s[4:5], 59400 glc
    s_load_dword s92, s[4:5], 61448 glc
    s_load_dword s93, s[4:5], 63496 glc
    buffer_store_dword v11, v7, s[8:11], s16 offen offset:8 sc1
    s_mov_b32 s31, 0
    s_waitcnt lgkmcnt(0)
    s_cmp_eq_u32 s62, s29
    s_addc_u32 s31, s31, 0
    s_cmp_eq_u32 s63, s29
    s_addc_u32 s31, s31, 0
    s_cmp_eq_u32 s64, s29
    s_addc_u32 s31, s31, 0
    s_cmp_eq_u32 s65, s29
    s_addc_u32 s31, s31, 0
    s_cmp_eq_u32 s66, s29
    s_addc_u32 s31, s31, 0
    s_cmp_eq_u32 s67, s29
    s_addc_u32 s31, s31, 0
    s_cmp_eq_u32 s68, s29
    s_addc_u32 s31, s31, 0
    s_cmp_eq_u32 s69, s29
    s_addc_u32 s31, s31, 0
    s_cmp_eq_u32 s70, s29
    s_addc_u32 s31, s31, 0
    s_cmp_eq_u32 s71, s29
    s_addc_u32 s31, s31, 0
    s_cmp_eq_u32 s72, s29
    s_addc_u32 s31, s31, 0
    s_cmp_eq_u32 s73, s29
    s_addc_u32 s31, s31, 0
    s_cmp_eq_u32 s74, s29
    s_addc_u32 s31, s31, 0
    s_cmp_eq_u32 s75, s29
    s_addc_u32 s31, s31, 0
    s_cmp_eq_u32 s76, s29
    s_addc_u32 s31, s31, 0
    s_cmp_eq_u32 s77, s29
    s_addc_u32 s31, s31, 0
    s_cmp_eq_u32 s78, s29
    s_addc_u32 s31, s31, 0
    s_cmp_eq_u32 s79, s29
    s_addc_u32 s31, s31, 0
    s_cmp_eq_u32 s80, s29
    s_addc_u32 s31, s31, 0
    s_cmp_eq_u32 s81, s29
    s_addc_u32 s31, s31, 0
    s_cmp_eq_u32 s82, s29
    s_addc_u32 s31, s31, 0
    s_cmp_eq_u32 s83, s29
    s_addc_u32 s31, s31, 0
    s_cmp_eq_u32 s84, s29
    s_addc_u32 s31, s31, 0
    s_cmp_eq_u32 s85, s29
    s_addc_u32 s31, s31, 0
    s_cmp_eq_u32 s86, s29
    s_addc_u32 s31, s31, 0
    s_cmp_eq_u32 s87, s29
    s_addc_u32 s31, s31, 0
    s_cmp_eq_u32 s88, s29
    s_addc_u32 s31, s31, 0
    s_cmp_eq_u32 s89, s29
    s_addc_u32 s31, s31, 0
    s_cmp_eq_u32 s90, s29
    s_addc_u32 s31, s31, 0
    s_cmp_eq_u32 s91, s29
    s_addc_u32 s31, s31, 0
    s_cmp_eq_u32 s92, s29
    s_addc_u32 s31, s31, 0
    s_cmp_eq_u32 s93, s29
    s_addc_u32 s31, s31, 0
    s_max_u32 s31, s31, 8
    s_sub_u32 s31, s31, 8
    s_mul_i32 s31, s31, s31
    s_mul_i32 s31, s31, 6
    s_lshr_b32 s31, s31, 6
    s_add_u32 s31, s31, 9
    v_mov_b32 v6, s31
    ds_write_b32 v4, v6 offset:12
L_merge:
    s_lshl_b32 s17, s20, 11
    s_lshl_b32 s18, s21, 8
    s_add_u32 s17, s17, s18
    s_add_u32 s17, s17, 0
    s_lshl_b32 s19, s20, 7
    s_lshl_b32 s18, s21, 2
    s_add_u32 s19, s19, s18
    s_add_u32 s19, s19, 65536
    v_lshl_add_u32 v8, v1, 3, s22
    v_lshlrev_b32 v9, 2, v1
    v_mov_b32 v10, s22
    v_lshlrev_b32 v11, 6, v1
    v_mov_b32 v12, 0x7fffff00
    v_cmp_gt_u32 vcc, 2, v1
    s_nop 1
    v_cndmask_b32 v11, v12, v11, vcc
    v_cmp_eq_u32 s[28:29], 0, v1
    s_cmp_eq_u32 s21, 7
    s_cbranch_scc1 L_nb2
    s_barrier
L_nb2:
    ds_read_b64 v[24:25], v10 offset:768
    ds_read_b64 v[26:27], v10 offset:1344
    ds_read_b64 v[16:17], v8 offset:256
    ds_read_b64 v[18:19], v8 offset:832
    s_waitcnt lgkmcnt(2)
    v_max_f32 v32, v24, v26
    v_sub_f32 v24, v24, v32
    v_sub_f32 v26, v26, v32
    v_mul_f32 v24, s24, v24
    v_mul_f32 v26, s24, v26
    v_exp_f32 v24, v24
    v_exp_f32 v26, v26
    v_mul_f32 v33, v24, v25
    v_fmac_f32 v33, v26, v27
    s_waitcnt lgkmcnt(0)
    v_rcp_f32 v34, v33
    v_mul_f32 v16, v24, v16
    v_mul_f32 v17, v24, v17
    v_fmac_f32 v16, v26, v18
    v_fmac_f32 v17, v26, v19
    v_cndmask_b32 v33, v33, v32, s[28:29]
    v_mul_f32 v16, v34, v16
    v_mul_f32 v17, v34, v17
    v_min_u32 v33, -2, v33
    v_cvt_pk_bf16_f32 v16, v16, v17
    v_min_u32 v16, -2, v16
    s_cmp_lg_u32 s35, 0
    s_cbranch_scc1 L_pwt
    buffer_store_dword v16, v9, s[8:11], s17 offen
    buffer_store_dword v33, v11, s[8:11], s19 offen
    s_branch L_pdone
L_pwt:
    buffer_store_dword v16, v9, s[8:11], s17 offen sc1
    buffer_store_dword v33, v11, s[8:11], s19 offen sc1
L_pdone:
    s_cmp_eq_u32 s21, 7
    s_cbranch_scc1 L_setup
    s_endpgm
L_svc:
    s_cmp_eq_u32 s3, 7
    s_cbranch_scc1 L_sq
    s_cmp_lg_u32 s3, 6
    s_cbranch_scc1 L_sb
    s_waitcnt lgkmcnt(0)
    s_mov_b32 s12, s60
    s_mov_b32 s13, s61
    s_mov_b32 s14, 0x68000
    s_mov_b32 s15, 0x20000
    v_mov_b32 v24, -1
    v_mov_b32 v25, -1
    v_mov_b32 v26, -1
    v_mov_b32 v27, -1
    v_lshlrev_b32 v28, 4, v1
    s_lshl_b32 s31, s20, 11
    s_add_u32 s31, s31, 0
    buffer_store_dwordx4 v[24:27], v28, s[12:15], s31 offen sc1
    buffer_store_dwordx4 v[24:27], v28, s[12:15], s31 offen offset:1024 sc1
    s_lshl_b32 s31, s20, 7
    s_add_u32 s31, s31, 65536
    v_mov_b32 v29, 0x7fffff00
    v_cmp_gt_u32 vcc, 8, v1
    s_nop 1
    v_cndmask_b32 v28, v29, v28, vcc
    buffer_store_dwordx4 v[24:27], v28, s[12:15], s31 offen sc1
    s_waitcnt vmcnt(0)
L_sb:
    s_barrier
    s_barrier
    s_cmp_lt_u32 s3, 5
    s_cbranch_scc1 L_ffn
    s_branch L_wo
L_sq:
    s_setprio 3
    v_lshlrev_b32 v32, 2, v1
    v_lshlrev_b32 v12, 13, v3
    v_lshl_add_u32 v12, v2, 4, v12
    v_lshlrev_b32 v33, 3, v2
    v_lshl_add_u32 v33, v3, 1, v33
    v_mov_b32 v13, 0
    s_mul_i32 s18, s21, 144
    s_mul_i32 s19, s21, 589824
    s_lshl_b32 s16, s20, 8
    s_add_u32 s16, s16, s19
    s_lshl_b32 s33, s20, 12
    s_add_u32 s33, s33, 81920
    s_lshl_b32 s19, s21, 9
    s_add_u32 s19, s19, s33
    s_mov_b32 s17, 69632
    s_waitcnt lgkmcnt(0)
    s_mov_b32 s8, s36
    s_mov_b32 s9, s37
    s_mov_b32 s10, 0x480
    s_mov_b32 s11, 0x20000
    s_mov_b32 s12, s60
    s_mov_b32 s13, s61
    s_mov_b32 s14, 0x68000
    s_mov_b32 s15, 0x20000
    buffer_load_dword v4, v32, s[8:11], 0 offen offset:0
    buffer_load_dword v5, v32, s[8:11], 0 offen offset:256
    buffer_load_dword v6, v32, s[8:11], 0 offen offset:512
    buffer_load_dword v7, v32, s[8:11], 0 offen offset:768
    buffer_load_dword v8, v32, s[8:11], 0 offen offset:1024
    buffer_load_ushort v9, v33, s[8:11], s18 offen offset:0
    buffer_load_ushort v10, v33, s[8:11], s18 offen offset:128
    buffer_load_dword v11, v13, s[12:15], s17 offen sc1
    s_mov_b32 s12, s42
    s_mov_b32 s13, s43
    s_mov_b32 s14, 0x480000
    s_mov_b32 s15, 0x20000
    buffer_load_dwordx4 v[64:67], v12, s[12:15], s16 offen nt
    s_add_u32 s16, s16, 0x8000
    buffer_load_dwordx4 v[68:71], v12, s[12:15], s16 offen nt
    s_add_u32 s16, s16, 0x8000
    buffer_load_dwordx4 v[72:75], v12, s[12:15], s16 offen nt
    s_add_u32 s16, s16, 0x8000
    buffer_load_dwordx4 v[76:79], v12, s[12:15], s16 offen nt
    s_add_u32 s16, s16, 0x8000
    buffer_load_dwordx4 v[80:83], v12, s[12:15], s16 offen nt
    s_add_u32 s16, s16, 0x8000
    buffer_load_dwordx4 v[84:87], v12, s[12:15], s16 offen nt
    s_add_u32 s16, s16, 0x8000
    buffer_load_dwordx4 v[88:91], v12, s[12:15], s16 offen nt
    s_add_u32 s16, s16, 0x8000
    buffer_load_dwordx4 v[92:95], v12, s[12:15], s16 offen nt
    s_add_u32 s16, s16, 0x8000
    buffer_load_dwordx4 v[96:99], v12, s[12:15], s16 offen nt
    s_add_u32 s16, s16, 0x8000
    buffer_load_dwordx4 v[100:103], v12, s[12:15], s16 offen nt
    s_add_u32 s16, s16, 0x8000
    buffer_load_dwordx4 v[104:107], v12, s[12:15], s16 offen nt
    s_add_u32 s16, s16, 0x8000
    buffer_load_dwordx4 v[108:111], v12, s[12:15], s16 offen nt
    s_add_u32 s16, s16, 0x8000
    buffer_load_dwordx4 v[112:115], v12, s[12:15], s16 offen nt
    s_add_u32 s16, s16, 0x8000
    buffer_load_dwordx4 v[116:119], v12, s[12:15], s16 offen nt
    s_add_u32 s16, s16, 0x8000
    buffer_load_dwordx4 v[120:123], v12, s[12:15], s16 offen nt
    s_add_u32 s16, s16, 0x8000
    buffer_load_dwordx4 v[124:127], v12, s[12:15], s16 offen nt
    s_add_u32 s16, s16, 0x8000
    buffer_load_dwordx4 v[128:131], v12, s[12:15], s16 offen nt
    s_add_u32 s16, s16, 0x8000
    buffer_load_dwordx4 v[132:135], v12, s[12:15], s16 offen nt
    s_mov_b32 s8, s60
    s_mov_b32 s9, s61
    s_mov_b32 s10, 0x68000
    s_mov_b32 s11, 0x20000
    v_and_b32 v34, 1, v2
    v_cmp_eq_u32 vcc, 0, v34
    v_mov_b32 v35, 0xffff0000
    v_mov_b32 v36, 0xffff
    v_cndmask_b32 v34, v35, v36, vcc
    v_lshrrev_b32 v35, 1, v2
    v_cmp_eq_u32 vcc, 0, v35
    s_nop 1
    v_cndmask_b32 v14, 0, v34, vcc
    v_cmp_eq_u32 vcc, 1, v35
    s_nop 1
    v_cndmask_b32 v15, 0, v34, vcc
    v_cmp_eq_u32 vcc, 2, v35
    s_nop 1
    v_cndmask_b32 v16, 0, v34, vcc
    v_cmp_eq_u32 vcc, 3, v35
    s_nop 1
    v_cndmask_b32 v17, 0, v34, vcc
    v_and_b32 v32, 1, v3
    v_lshlrev_b32 v32, 1, v32
    v_lshl_add_u32 v32, v2, 2, v32
    v_lshrrev_b32 v33, 1, v3
    v_add_lshl_u32 v13, v32, v33, 3
    s_waitcnt vmcnt(21)
    v_lshlrev_b32 v36, 16, v4
    v_and_b32 v37, 0xffff0000, v4
    v_lshlrev_b32 v38, 16, v5
    v_and_b32 v39, 0xffff0000, v5
    v_lshlrev_b32 v40, 16, v6
    v_and_b32 v41, 0xffff0000, v6
    v_lshlrev_b32 v42, 16, v7
    v_and_b32 v43, 0xffff0000, v7
    v_lshlrev_b32 v44, 16, v8
    v_and_b32 v45, 0xffff0000, v8
    v_add_f32 v46, v36, v37
    v_add_f32 v46, v46, v38
    v_add_f32 v46, v46, v39
    v_add_f32 v46, v46, v40
    v_add_f32 v46, v46, v41
    v_add_f32 v46, v46, v42
    v_add_f32 v46, v46, v43
    v_add_f32 v46, v46, v44
    v_add_f32 v46, v46, v45
    s_nop 1
    v_add_f32_dpp v46, v46, v46 row_ror:8 row_mask:0xf bank_mask:0xf
    s_nop 1
    v_add_f32_dpp v46, v46, v46 row_ror:4 row_mask:0xf bank_mask:0xf
    s_nop 1
    v_add_f32_dpp v46, v46, v46 row_ror:2 row_mask:0xf bank_mask:0xf
    s_nop 1
    v_add_f32_dpp v46, v46, v46 row_ror:1 row_mask:0xf bank_mask:0xf
    v_mov_b32 v47, v46
    s_nop 1
    v_permlane16_swap_b32 v47, v46
    v_add_f32 v46, v47, v46
    v_mov_b32 v47, v46
    s_nop 1
    v_permlane32_swap_b32 v47, v46
    v_add_f32 v46, v47, v46
    v_mul_f32 v46, 0x3ae38e39, v46
    v_sub_f32 v36, v36, v46
    v_sub_f32 v37, v37, v46
    v_sub_f32 v38, v38, v46
    v_sub_f32 v39, v39, v46
    v_sub_f32 v40, v40, v46
    v_sub_f32 v41, v41, v46
    v_sub_f32 v42, v42, v46
    v_sub_f32 v43, v43, v46
    v_sub_f32 v44, v44, v46
    v_sub_f32 v45, v45, v46
    v_cmp_gt_u32 vcc, 32, v1
    s_nop 1
    v_cndmask_b32 v44, 0, v44, vcc
    v_cndmask_b32 v45, 0, v45, vcc
    v_mul_f32 v48, v36, v36
    v_fmac_f32 v48, v37, v37
    v_fmac_f32 v48, v38, v38
    v_fmac_f32 v48, v39, v39
    v_fmac_f32 v48, v40, v40
    v_fmac_f32 v48, v41, v41
    v_fmac_f32 v48, v42, v42
    v_fmac_f32 v48, v43, v43
    v_fmac_f32 v48, v44, v44
    v_fmac_f32 v48, v45, v45
    s_nop 1
    v_add_f32_dpp v48, v48, v48 row_ror:8 row_mask:0xf bank_mask:0xf
    s_nop 1
    v_add_f32_dpp v48, v48, v48 row_ror:4 row_mask:0xf bank_mask:0xf
    s_nop 1
    v_add_f32_dpp v48, v48, v48 row_ror:2 row_mask:0xf bank_mask:0xf
    s_nop 1
    v_add_f32_dpp v48, v48, v48 row_ror:1 row_mask:0xf bank_mask:0xf
    v_mov_b32 v47, v48
    s_nop 1
    v_permlane16_swap_b32 v47, v48
    v_add_f32 v48, v47, v48
    v_mov_b32 v47, v48
    s_nop 1
    v_permlane32_swap_b32 v47, v48
    v_add_f32 v48, v47, v48
    v_mul_f32 v19, 0x3ae38e39, v48
    v_mov_b32 v18, v46
    v_cvt_pk_bf16_f32 v18, v18, v18
    v_and_b32 v18, 0xffff0000, v18
    v_cvt_pk_bf16_f32 v19, v19, v19
    v_and_b32 v19, 0xffff0000, v19
    v_add_f32 v19, 0x3727c5ac, v19
    v_cvt_pk_bf16_f32 v19, v19, v19
    v_and_b32 v19, 0xffff0000, v19
    v_sqrt_f32 v19, v19
    s_nop 0
    v_cvt_pk_bf16_f32 v19, v19, v19
    v_and_b32 v19, 0xffff0000, v19
    v_rcp_f32 v19, v19
    s_waitcnt vmcnt(18)
    v_lshlrev_b32 v9, 16, v9
    v_sub_f32 v9, v9, v18
    v_cvt_pk_bf16_f32 v9, v9, v9
    v_and_b32 v9, 0xffff0000, v9
    v_mul_f32 v9, v9, v19
    v_cvt_pk_bf16_f32 v9, v9, v9
    v_lshlrev_b32 v10, 16, v10
    v_sub_f32 v10, v10, v18
    v_cvt_pk_bf16_f32 v10, v10, v10
    v_and_b32 v10, 0xffff0000, v10
    v_mul_f32 v10, v10, v19
    v_cvt_pk_bf16_f32 v10, v10, v10
    s_mov_b32 s16, 1664525
    v_mul_lo_u32 v11, v11, s16
    v_add_u32 v11, 0x3c6ef35f, v11
    v_and_b32_dpp v24, v9, v14 row_newbcast:0 row_mask:0xf bank_mask:0xf
    v_and_b32_dpp v25, v9, v15 row_newbcast:0 row_mask:0xf bank_mask:0xf
    v_and_b32_dpp v26, v9, v16 row_newbcast:0 row_mask:0xf bank_mask:0xf
    v_and_b32_dpp v27, v9, v17 row_newbcast:0 row_mask:0xf bank_mask:0xf
    v_and_b32_dpp v28, v9, v14 row_newbcast:1 row_mask:0xf bank_mask:0xf
    v_and_b32_dpp v29, v9, v15 row_newbcast:1 row_mask:0xf bank_mask:0xf
    v_and_b32_dpp v30, v9, v16 row_newbcast:1 row_mask:0xf bank_mask:0xf
    v_and_b32_dpp v31, v9, v17 row_newbcast:1 row_mask:0xf bank_mask:0xf
    s_waitcnt vmcnt(17)
    v_mfma_f32_16x16x32_bf16 v[20:23], v[24:27], v[64:67], 0
    v_and_b32_dpp v24, v9, v14 row_newbcast:2 row_mask:0xf bank_mask:0xf
    v_and_b32_dpp v25, v9, v15 row_newbcast:2 row_mask:0xf bank_mask:0xf
    v_and_b32_dpp v26, v9, v16 row_newbcast:2 row_mask:0xf bank_mask:0xf
    v_and_b32_dpp v27, v9, v17 row_newbcast:2 row_mask:0xf bank_mask:0xf
    s_waitcnt vmcnt(16)
    v_mfma_f32_16x16x32_bf16 v[20:23], v[28:31], v[68:71], v[20:23]
    v_and_b32_dpp v28, v9, v14 row_newbcast:3 row_mask:0xf bank_mask:0xf
    v_and_b32_dpp v29, v9, v15 row_newbcast:3 row_mask:0xf bank_mask:0xf
    v_and_b32_dpp v30, v9, v16 row_newbcast:3 row_mask:0xf bank_mask:0xf
    v_and_b32_dpp v31, v9, v17 row_newbcast:3 row_mask:0xf bank_mask:0xf
    s_waitcnt vmcnt(15)
    v_mfma_f32_16x16x32_bf16 v[20:23], v[24:27], v[72:75], v[20:23]
    v_and_b32_dpp v24, v9, v14 row_newbcast:4 row_mask:0xf bank_mask:0xf
    v_and_b32_dpp v25, v9, v15 row_newbcast:4 row_mask:0xf bank_mask:0xf
    v_and_b32_dpp v26, v9, v16 row_newbcast:4 row_mask:0xf bank_mask:0xf
    v_and_b32_dpp v27, v9, v17 row_newbcast:4 row_mask:0xf bank_mask:0xf
    s_waitcnt vmcnt(14)
    v_mfma_f32_16x16x32_bf16 v[20:23], v[28:31], v[76:79], v[20:23]
    v_and_b32_dpp v28, v9, v14 row_newbcast:5 row_mask:0xf bank_mask:0xf
    v_and_b32_dpp v29, v9, v15 row_newbcast:5 row_mask:0xf bank_mask:0xf
    v_and_b32_dpp v30, v9, v16 row_newbcast:5 row_mask:0xf bank_mask:0xf
    v_and_b32_dpp v31, v9, v17 row_newbcast:5 row_mask:0xf bank_mask:0xf
    s_waitcnt vmcnt(13)
    v_mfma_f32_16x16x32_bf16 v[20:23], v[24:27], v[80:83], v[20:23]
    v_and_b32_dpp v24, v9, v14 row_newbcast:6 row_mask:0xf bank_mask:0xf
    v_and_b32_dpp v25, v9, v15 row_newbcast:6 row_mask:0xf bank_mask:0xf
    v_and_b32_dpp v26, v9, v16 row_newbcast:6 row_mask:0xf bank_mask:0xf
    v_and_b32_dpp v27, v9, v17 row_newbcast:6 row_mask:0xf bank_mask:0xf
    s_waitcnt vmcnt(12)
    v_mfma_f32_16x16x32_bf16 v[20:23], v[28:31], v[84:87], v[20:23]
    v_and_b32_dpp v28, v9, v14 row_newbcast:7 row_mask:0xf bank_mask:0xf
    v_and_b32_dpp v29, v9, v15 row_newbcast:7 row_mask:0xf bank_mask:0xf
    v_and_b32_dpp v30, v9, v16 row_newbcast:7 row_mask:0xf bank_mask:0xf
    v_and_b32_dpp v31, v9, v17 row_newbcast:7 row_mask:0xf bank_mask:0xf
    s_waitcnt vmcnt(11)
    v_mfma_f32_16x16x32_bf16 v[20:23], v[24:27], v[88:91], v[20:23]
    v_and_b32_dpp v24, v9, v14 row_newbcast:8 row_mask:0xf bank_mask:0xf
    v_and_b32_dpp v25, v9, v15 row_newbcast:8 row_mask:0xf bank_mask:0xf
    v_and_b32_dpp v26, v9, v16 row_newbcast:8 row_mask:0xf bank_mask:0xf
    v_and_b32_dpp v27, v9, v17 row_newbcast:8 row_mask:0xf bank_mask:0xf
    s_waitcnt vmcnt(10)
    v_mfma_f32_16x16x32_bf16 v[20:23], v[28:31], v[92:95], v[20:23]
    v_and_b32_dpp v28, v9, v14 row_newbcast:9 row_mask:0xf bank_mask:0xf
    v_and_b32_dpp v29, v9, v15 row_newbcast:9 row_mask:0xf bank_mask:0xf
    v_and_b32_dpp v30, v9, v16 row_newbcast:9 row_mask:0xf bank_mask:0xf
    v_and_b32_dpp v31, v9, v17 row_newbcast:9 row_mask:0xf bank_mask:0xf
    s_waitcnt vmcnt(9)
    v_mfma_f32_16x16x32_bf16 v[20:23], v[24:27], v[96:99], v[20:23]
    v_and_b32_dpp v24, v9, v14 row_newbcast:10 row_mask:0xf bank_mask:0xf
    v_and_b32_dpp v25, v9, v15 row_newbcast:10 row_mask:0xf bank_mask:0xf
    v_and_b32_dpp v26, v9, v16 row_newbcast:10 row_mask:0xf bank_mask:0xf
    v_and_b32_dpp v27, v9, v17 row_newbcast:10 row_mask:0xf bank_mask:0xf
    s_waitcnt vmcnt(8)
    v_mfma_f32_16x16x32_bf16 v[20:23], v[28:31], v[100:103], v[20:23]
    v_and_b32_dpp v28, v9, v14 row_newbcast:11 row_mask:0xf bank_mask:0xf
    v_and_b32_dpp v29, v9, v15 row_newbcast:11 row_mask:0xf bank_mask:0xf
    v_and_b32_dpp v30, v9, v16 row_newbcast:11 row_mask:0xf bank_mask:0xf
    v_and_b32_dpp v31, v9, v17 row_newbcast:11 row_mask:0xf bank_mask:0xf
    s_waitcnt vmcnt(7)
    v_mfma_f32_16x16x32_bf16 v[20:23], v[24:27], v[104:107], v[20:23]
    v_and_b32_dpp v24, v9, v14 row_newbcast:12 row_mask:0xf bank_mask:0xf
    v_and_b32_dpp v25, v9, v15 row_newbcast:12 row_mask:0xf bank_mask:0xf
    v_and_b32_dpp v26, v9, v16 row_newbcast:12 row_mask:0xf bank_mask:0xf
    v_and_b32_dpp v27, v9, v17 row_newbcast:12 row_mask:0xf bank_mask:0xf
    s_waitcnt vmcnt(6)
    v_mfma_f32_16x16x32_bf16 v[20:23], v[28:31], v[108:111], v[20:23]
    v_and_b32_dpp v28, v9, v14 row_newbcast:13 row_mask:0xf bank_mask:0xf
    v_and_b32_dpp v29, v9, v15 row_newbcast:13 row_mask:0xf bank_mask:0xf
    v_and_b32_dpp v30, v9, v16 row_newbcast:13 row_mask:0xf bank_mask:0xf
    v_and_b32_dpp v31, v9, v17 row_newbcast:13 row_mask:0xf bank_mask:0xf
    s_waitcnt vmcnt(5)
    v_mfma_f32_16x16x32_bf16 v[20:23], v[24:27], v[112:115], v[20:23]
    v_and_b32_dpp v24, v9, v14 row_newbcast:14 row_mask:0xf bank_mask:0xf
    v_and_b32_dpp v25, v9, v15 row_newbcast:14 row_mask:0xf bank_mask:0xf
    v_and_b32_dpp v26, v9, v16 row_newbcast:14 row_mask:0xf bank_mask:0xf
    v_and_b32_dpp v27, v9, v17 row_newbcast:14 row_mask:0xf bank_mask:0xf
    s_waitcnt vmcnt(4)
    v_mfma_f32_16x16x32_bf16 v[20:23], v[28:31], v[116:119], v[20:23]
    v_and_b32_dpp v28, v9, v14 row_newbcast:15 row_mask:0xf bank_mask:0xf
    v_and_b32_dpp v29, v9, v15 row_newbcast:15 row_mask:0xf bank_mask:0xf
    v_and_b32_dpp v30, v9, v16 row_newbcast:15 row_mask:0xf bank_mask:0xf
    v_and_b32_dpp v31, v9, v17 row_newbcast:15 row_mask:0xf bank_mask:0xf
    s_waitcnt vmcnt(3)
    v_mfma_f32_16x16x32_bf16 v[20:23], v[24:27], v[120:123], v[20:23]
    v_and_b32_dpp v24, v10, v14 row_newbcast:0 row_mask:0xf bank_mask:0xf
    v_and_b32_dpp v25, v10, v15 row_newbcast:0 row_mask:0xf bank_mask:0xf
    v_and_b32_dpp v26, v10, v16 row_newbcast:0 row_mask:0xf bank_mask:0xf
    v_and_b32_dpp v27, v10, v17 row_newbcast:0 row_mask:0xf bank_mask:0xf
    s_waitcnt vmcnt(2)
    v_mfma_f32_16x16x32_bf16 v[20:23], v[28:31], v[124:127], v[20:23]
    v_and_b32_dpp v28, v10, v14 row_newbcast:1 row_mask:0xf bank_mask:0xf
    v_and_b32_dpp v29, v10, v15 row_newbcast:1 row_mask:0xf bank_mask:0xf
    v_and_b32_dpp v30, v10, v16 row_newbcast:1 row_mask:0xf bank_mask:0xf
    v_and_b32_dpp v31, v10, v17 row_newbcast:1 row_mask:0xf bank_mask:0xf
    s_waitcnt vmcnt(1)
    v_mfma_f32_16x16x32_bf16 v[20:23], v[24:27], v[128:131], v[20:23]
    s_waitcnt vmcnt(0)
    v_mfma_f32_16x16x32_bf16 v[20:23], v[28:31], v[132:135], v[20:23]
    s_nop 7
    v_permlane32_swap_b32 v20, v22
    v_permlane32_swap_b32 v21, v23
    v_add_u32 v20, 8, v20
    v_bfi_b32 v20, 15, v11, v20
    v_add_u32 v21, 8, v21
    v_bfi_b32 v21, 15, v11, v21
    s_getreg_b32 s34, hwreg(HW_REG_XCC_ID, 0, 3)
    s_lshl_b32 s34, s34, 4
    v_mov_b32 v28, s34
    v_mov_b32 v29, 0x70
    s_mov_b64 exec, 1
    v_bfi_b32 v20, v29, v28, v20
    s_mov_b64 exec, -1
    s_barrier
    buffer_store_dwordx2 v[20:21], v13, s[8:11], s19 offen sc1
    v_lshlrev_b32 v4, 3, v1
    s_mov_b32 s30, 65536
    s_waitcnt vmcnt(0)
L_qs:
    buffer_load_dwordx2 v[64:65], v4, s[8:11], s33 offen offset:0 sc1
    buffer_load_dwordx2 v[66:67], v4, s[8:11], s33 offen offset:512 sc1
    buffer_load_dwordx2 v[68:69], v4, s[8:11], s33 offen offset:1024 sc1
    buffer_load_dwordx2 v[70:71], v4, s[8:11], s33 offen offset:1536 sc1
    buffer_load_dwordx2 v[72:73], v4, s[8:11], s33 offen offset:2048 sc1
    buffer_load_dwordx2 v[74:75], v4, s[8:11], s33 offen offset:2560 sc1
    buffer_load_dwordx2 v[76:77], v4, s[8:11], s33 offen offset:3072 sc1
    buffer_load_dwordx2 v[78:79], v4, s[8:11], s33 offen offset:3584 sc1
    s_waitcnt vmcnt(0)
    v_xor_b32 v5, v64, v11
    v_xor_b32 v6, v65, v11
    v_xor_b32 v7, v66, v11
    v_xor_b32 v8, v67, v11
    v_or3_b32 v5, v5, v7, v8
    v_xor_b32 v7, v68, v11
    v_xor_b32 v8, v69, v11
    v_or3_b32 v5, v5, v7, v8
    v_xor_b32 v7, v70, v11
    v_xor_b32 v8, v71, v11
    v_or3_b32 v5, v5, v7, v8
    v_xor_b32 v7, v72, v11
    v_xor_b32 v8, v73, v11
    v_or3_b32 v5, v5, v7, v8
    v_xor_b32 v7, v74, v11
    v_xor_b32 v8, v75, v11
    v_or3_b32 v5, v5, v7, v8
    v_xor_b32 v7, v76, v11
    v_xor_b32 v8, v77, v11
    v_or3_b32 v5, v5, v7, v8
    v_xor_b32 v7, v78, v11
    v_xor_b32 v8, v79, v11
    v_or3_b32 v5, v5, v7, v8
    v_or_b32 v5, v5, v6
    v_and_b32 v5, 15, v5
    v_cmp_ne_u32 vcc, 0, v5
    s_nop 1
    s_cbranch_vccz L_qs_ok
    s_sub_u32 s30, s30, 1
    s_cmp_lg_u32 s30, 0
    s_cbranch_scc1 L_qs
L_qs_ok:
    v_lshl_add_u32 v9, v1, 2, s22
    v_mov_b32 v30, -16
    s_mov_b64 exec, 1
    v_mov_b32 v30, 0xffffff80
    s_mov_b64 exec, -1
    v_and_b32 v80, v30, v64
    v_and_b32 v81, -16, v65
    v_and_b32 v82, v30, v66
    v_and_b32 v83, -16, v67
    v_and_b32 v84, v30, v68
    v_and_b32 v85, -16, v69
    v_and_b32 v86, v30, v70
    v_and_b32 v87, -16, v71
    v_and_b32 v88, v30, v72
    v_and_b32 v89, -16, v73
    v_and_b32 v90, v30, v74
    v_and_b32 v91, -16, v75
    v_and_b32 v92, v30, v76
    v_and_b32 v93, -16, v77
    v_and_b32 v94, v30, v78
    v_and_b32 v95, -16, v79
    v_add_f32 v80, v80, v88
    v_add_f32 v81, v81, v89
    v_add_f32 v82, v82, v90
    v_add_f32 v83, v83, v91
    v_add_f32 v84, v84, v92
    v_add_f32 v85, v85, v93
    v_add_f32 v86, v86, v94
    v_add_f32 v87, v87, v95
    v_add_f32 v80, v80, v84
    v_add_f32 v81, v81, v85
    v_add_f32 v82, v82, v86
    v_add_f32 v83, v83, v87
    v_add_f32 v80, v80, v82
    v_add_f32 v81, v81, v83
    v_cvt_pk_bf16_f32 v5, v80, v81
    ds_write_b32 v9, v5 offset:0
    s_setprio 0
    v_mov_b32 v4, 154816
    v_mov_b32 v12, 0
    v_mov_b32 v13, 0
    ds_write_b32 v4, v11
    ds_write_b64 v4, v[12:13] offset:8
    s_waitcnt lgkmcnt(0)
    s_barrier
    s_branch L_s1
L_wo:
    s_waitcnt lgkmcnt(0)
    s_mov_b32 s12, s44
    s_mov_b32 s13, s45
    s_mov_b32 s14, 0x480000
    s_mov_b32 s15, 0x20000
    s_sub_u32 s17, s3, 5
    s_lshl_b32 s17, s17, 10
    s_mul_i32 s16, s20, 147456
    s_add_u32 s16, s16, s17
    s_add_u32 m0, s17, 0
    v_lshlrev_b32 v4, 4, v1
    s_mov_b32 s31, 72
L_dwo:
    s_waitcnt vmcnt(3)
    buffer_load_dwordx4 v4, s[12:15], s16 offen nt lds
    s_add_u32 m0, m0, 0x800
    s_add_u32 s16, s16, 0x800
    s_sub_u32 s31, s31, 1
    s_cmp_lg_u32 s31, 0
    s_cbranch_scc1 L_dwo
    s_waitcnt vmcnt(0)
    s_branch L_s1
L_ffn:
    s_sub_u32 s35, s3, 2
    s_lshl_b32 s17, s20, 1
    s_add_u32 s17, s17, s35
    s_add_u32 s18, s20, 64
    s_cmp_lt_u32 s35, 2
    s_cselect_b32 s17, s17, s18
    s_mul_i32 s18, s35, 2304
    s_add_u32 s18, s18, 147904
    v_lshl_add_u32 v10, v2, 4, s18
    v_mov_b32 v104, 0
    v_mov_b32 v105, 0
    v_mov_b32 v106, 0
    v_mov_b32 v107, 0
    v_mov_b32 v108, 0
    v_mov_b32 v109, 0
    v_mov_b32 v110, 0
    v_mov_b32 v111, 0
    v_mov_b32 v112, 0
    v_mov_b32 v113, 0
    v_mov_b32 v114, 0
    v_mov_b32 v115, 0
    v_mov_b32 v116, 0
    v_mov_b32 v117, 0
    v_mov_b32 v118, 0
    v_mov_b32 v119, 0
    v_mov_b32 v120, 0
    v_mov_b32 v121, 0
    v_mov_b32 v122, 0
    v_mov_b32 v123, 0
    v_mov_b32 v124, 0
    v_mov_b32 v125, 0
    v_mov_b32 v126, 0
    v_mov_b32 v127, 0
    v_mov_b32 v128, 0
    v_mov_b32 v129, 0
    v_mov_b32 v130, 0
    v_mov_b32 v131, 0
    v_mov_b32 v132, 0
    v_mov_b32 v133, 0
    v_mov_b32 v134, 0
    v_mov_b32 v135, 0
    v_mov_b32 v136, 0
    v_mov_b32 v137, 0
    v_mov_b32 v138, 0
    v_mov_b32 v139, 0
    s_waitcnt lgkmcnt(0)
    s_cmp_ge_u32 s17, 72
    s_cbranch_scc1 L_fy
    s_mov_b32 s8, s36
    s_mov_b32 s9, s37
    s_mov_b32 s10, 0x480
    s_mov_b32 s11, 0x20000
    s_mov_b32 s12, s48
    s_mov_b32 s13, s49
    s_mov_b32 s14, 0x510000
    s_mov_b32 s15, 0x20000
    v_lshlrev_b32 v32, 2, v1
    v_lshlrev_b32 v33, 3, v2
    v_lshl_add_u32 v34, v3, 1, v33
    buffer_load_dword v4, v32, s[8:11], 0 offen offset:0
    buffer_load_dword v5, v32, s[8:11], 0 offen offset:256
    buffer_load_dword v6, v32, s[8:11], 0 offen offset:512
    buffer_load_dword v7, v32, s[8:11], 0 offen offset:768
    buffer_load_dword v8, v32, s[8:11], 0 offen offset:1024
    buffer_load_ushort v48, v34, s[8:11], 0 offen offset:0
    buffer_load_ushort v49, v34, s[8:11], 0 offen offset:128
    buffer_load_ushort v50, v34, s[8:11], 0 offen offset:256
    buffer_load_ushort v51, v34, s[8:11], 0 offen offset:384
    buffer_load_ushort v52, v34, s[8:11], 0 offen offset:512
    buffer_load_ushort v53, v34, s[8:11], 0 offen offset:640
    buffer_load_ushort v54, v34, s[8:11], 0 offen offset:768
    buffer_load_ushort v55, v34, s[8:11], 0 offen offset:896
    buffer_load_ushort v56, v34, s[8:11], 0 offen offset:1024
    v_mul_u32_u24 v12, 9216, v3
    v_add_u32 v12, v12, v33
    s_lshl_b32 s16, s17, 7
    s_mov_b32 s19, s16
    s_mov_b32 s8, s50
    s_mov_b32 s9, s51
    s_mov_b32 s10, 0x2400
    s_mov_b32 s11, 0x20000
    buffer_load_dwordx2 v[60:61], v33, s[8:11], s19 offen
    buffer_load_dwordx2 v[64:65], v12, s[12:15], s16 offen nt
    s_add_u32 s16, s16, 36864
    buffer_load_dwordx2 v[66:67], v12, s[12:15], s16 offen nt
    s_add_u32 s16, s16, 36864
    buffer_load_dwordx2 v[68:69], v12, s[12:15], s16 offen nt
    s_add_u32 s16, s16, 36864
    buffer_load_dwordx2 v[70:71], v12, s[12:15], s16 offen nt
    s_add_u32 s16, s16, 36864
    buffer_load_dwordx2 v[72:73], v12, s[12:15], s16 offen nt
    s_add_u32 s16, s16, 36864
    buffer_load_dwordx2 v[74:75], v12, s[12:15], s16 offen nt
    s_add_u32 s16, s16, 36864
    buffer_load_dwordx2 v[76:77], v12, s[12:15], s16 offen nt
    s_add_u32 s16, s16, 36864
    buffer_load_dwordx2 v[78:79], v12, s[12:15], s16 offen nt
    s_add_u32 s16, s16, 36864
    buffer_load_dwordx2 v[80:81], v12, s[12:15], s16 offen nt
    s_add_u32 s16, s16, 36864
    buffer_load_dwordx2 v[82:83], v12, s[12:15], s16 offen nt
    s_add_u32 s16, s16, 36864
    buffer_load_dwordx2 v[84:85], v12, s[12:15], s16 offen nt
    s_add_u32 s16, s16, 36864
    buffer_load_dwordx2 v[86:87], v12, s[12:15], s16 offen nt
    s_add_u32 s16, s16, 36864
    s_lshl_b32 s18, s35, 7
    s_add_u32 s18, s18, 147520
    v_add_u32 v9, s18, v33
    v_lshl_add_u32 v11, v3, 1, s18
    v_mul_u32_u24 v13, 1152, v3
    v_add_u32 v13, v13, v33
    v_and_b32 v35, 1, v2
    v_cmp_eq_u32 vcc, 0, v35
    v_mov_b32 v36, 0xffff0000
    v_mov_b32 v37, 0xffff
    v_cndmask_b32 v35, v36, v37, vcc
    v_lshrrev_b32 v36, 1, v2
    v_cmp_eq_u32 vcc, 0, v36
    s_nop 1
    v_cndmask_b32 v14, 0, v35, vcc
    v_cmp_eq_u32 vcc, 1, v36
    s_nop 1
    v_cndmask_b32 v15, 0, v35, vcc
    s_waitcnt vmcnt(22)
    v_lshlrev_b32 v35, 16, v4
    v_and_b32 v36, 0xffff0000, v4
    v_lshlrev_b32 v37, 16, v5
    v_and_b32 v38, 0xffff0000, v5
    v_lshlrev_b32 v39, 16, v6
    v_and_b32 v40, 0xffff0000, v6
    v_lshlrev_b32 v41, 16, v7
    v_and_b32 v42, 0xffff0000, v7
    v_lshlrev_b32 v43, 16, v8
    v_and_b32 v44, 0xffff0000, v8
    v_add_f32 v45, v35, v36
    v_add_f32 v45, v45, v37
    v_add_f32 v45, v45, v38
    v_add_f32 v45, v45, v39
    v_add_f32 v45, v45, v40
    v_add_f32 v45, v45, v41
    v_add_f32 v45, v45, v42
    v_add_f32 v45, v45, v43
    v_add_f32 v45, v45, v44
    s_nop 1
    v_add_f32_dpp v45, v45, v45 row_ror:8 row_mask:0xf bank_mask:0xf
    s_nop 1
    v_add_f32_dpp v45, v45, v45 row_ror:4 row_mask:0xf bank_mask:0xf
    s_nop 1
    v_add_f32_dpp v45, v45, v45 row_ror:2 row_mask:0xf bank_mask:0xf
    s_nop 1
    v_add_f32_dpp v45, v45, v45 row_ror:1 row_mask:0xf bank_mask:0xf
    v_mov_b32 v46, v45
    s_nop 1
    v_permlane16_swap_b32 v46, v45
    v_add_f32 v45, v46, v45
    v_mov_b32 v46, v45
    s_nop 1
    v_permlane32_swap_b32 v46, v45
    v_add_f32 v45, v46, v45
    v_mul_f32 v45, 0x3ae38e39, v45
    v_sub_f32 v35, v35, v45
    v_sub_f32 v36, v36, v45
    v_sub_f32 v37, v37, v45
    v_sub_f32 v38, v38, v45
    v_sub_f32 v39, v39, v45
    v_sub_f32 v40, v40, v45
    v_sub_f32 v41, v41, v45
    v_sub_f32 v42, v42, v45
    v_sub_f32 v43, v43, v45
    v_sub_f32 v44, v44, v45
    v_cmp_gt_u32 vcc, 32, v1
    s_nop 1
    v_cndmask_b32 v43, 0, v43, vcc
    v_cndmask_b32 v44, 0, v44, vcc
    v_mul_f32 v47, v35, v35
    v_fmac_f32 v47, v36, v36
    v_fmac_f32 v47, v37, v37
    v_fmac_f32 v47, v38, v38
    v_fmac_f32 v47, v39, v39
    v_fmac_f32 v47, v40, v40
    v_fmac_f32 v47, v41, v41
    v_fmac_f32 v47, v42, v42
    v_fmac_f32 v47, v43, v43
    v_fmac_f32 v47, v44, v44
    s_nop 1
    v_add_f32_dpp v47, v47, v47 row_ror:8 row_mask:0xf bank_mask:0xf
    s_nop 1
    v_add_f32_dpp v47, v47, v47 row_ror:4 row_mask:0xf bank_mask:0xf
    s_nop 1
    v_add_f32_dpp v47, v47, v47 row_ror:2 row_mask:0xf bank_mask:0xf
    s_nop 1
    v_add_f32_dpp v47, v47, v47 row_ror:1 row_mask:0xf bank_mask:0xf
    v_mov_b32 v46, v47
    s_nop 1
    v_permlane16_swap_b32 v46, v47
    v_add_f32 v47, v46, v47
    v_mov_b32 v46, v47
    s_nop 1
    v_permlane32_swap_b32 v46, v47
    v_add_f32 v47, v46, v47
    v_mul_f32 v19, 0x3ae38e39, v47
    v_mov_b32 v18, v45
    v_cvt_pk_bf16_f32 v18, v18, v18
    v_and_b32 v18, 0xffff0000, v18
    v_cvt_pk_bf16_f32 v19, v19, v19
    v_and_b32 v19, 0xffff0000, v19
    v_add_f32 v19, 0x3727c5ac, v19
    v_cvt_pk_bf16_f32 v19, v19, v19
    v_and_b32 v19, 0xffff0000, v19
    v_sqrt_f32 v19, v19
    s_nop 0
    v_cvt_pk_bf16_f32 v19, v19, v19
    v_and_b32 v19, 0xffff0000, v19
    v_rcp_f32 v19, v19
    s_waitcnt vmcnt(12)
    v_lshlrev_b32 v48, 16, v48
    v_sub_f32 v48, v48, v18
    v_cvt_pk_bf16_f32 v48, v48, v48
    v_and_b32 v48, 0xffff0000, v48
    v_mul_f32 v48, v48, v19
    v_cvt_pk_bf16_f32 v48, v48, v48
    v_lshlrev_b32 v49, 16, v49
    v_sub_f32 v49, v49, v18
    v_cvt_pk_bf16_f32 v49, v49, v49
    v_and_b32 v49, 0xffff0000, v49
    v_mul_f32 v49, v49, v19
    v_cvt_pk_bf16_f32 v49, v49, v49
    v_lshlrev_b32 v50, 16, v50
    v_sub_f32 v50, v50, v18
    v_cvt_pk_bf16_f32 v50, v50, v50
    v_and_b32 v50, 0xffff0000, v50
    v_mul_f32 v50, v50, v19
    v_cvt_pk_bf16_f32 v50, v50, v50
    v_lshlrev_b32 v51, 16, v51
    v_sub_f32 v51, v51, v18
    v_cvt_pk_bf16_f32 v51, v51, v51
    v_and_b32 v51, 0xffff0000, v51
    v_mul_f32 v51, v51, v19
    v_cvt_pk_bf16_f32 v51, v51, v51
    v_lshlrev_b32 v52, 16, v52
    v_sub_f32 v52, v52, v18
    v_cvt_pk_bf16_f32 v52, v52, v52
    v_and_b32 v52, 0xffff0000, v52
    v_mul_f32 v52, v52, v19
    v_cvt_pk_bf16_f32 v52, v52, v52
    v_lshlrev_b32 v53, 16, v53
    v_sub_f32 v53, v53, v18
    v_cvt_pk_bf16_f32 v53, v53, v53
    v_and_b32 v53, 0xffff0000, v53
    v_mul_f32 v53, v53, v19
    v_cvt_pk_bf16_f32 v53, v53, v53
    v_lshlrev_b32 v54, 16, v54
    v_sub_f32 v54, v54, v18
    v_cvt_pk_bf16_f32 v54, v54, v54
    v_and_b32 v54, 0xffff0000, v54
    v_mul_f32 v54, v54, v19
    v_cvt_pk_bf16_f32 v54, v54, v54
    v_lshlrev_b32 v55, 16, v55
    v_sub_f32 v55, v55, v18
    v_cvt_pk_bf16_f32 v55, v55, v55
    v_and_b32 v55, 0xffff0000, v55
    v_mul_f32 v55, v55, v19
    v_cvt_pk_bf16_f32 v55, v55, v55
    v_lshlrev_b32 v56, 16, v56
    v_sub_f32 v56, v56, v18
    v_cvt_pk_bf16_f32 v56, v56, v56
    v_and_b32 v56, 0xffff0000, v56
    v_mul_f32 v56, v56, v19
    v_cvt_pk_bf16_f32 v56, v56, v56
    v_mov_b32 v20, 0
    v_mov_b32 v21, 0
    v_mov_b32 v22, 0
    v_mov_b32 v23, 0
    s_mov_b32 s31, 9
L_f1:
    v_and_b32_dpp v24, v48, v14 row_newbcast:0 row_mask:0xf bank_mask:0xf
    v_and_b32_dpp v25, v48, v15 row_newbcast:0 row_mask:0xf bank_mask:0xf
    s_waitcnt vmcnt(11)
    s_nop 0
    v_mfma_f32_16x16x16_bf16 v[20:23], v[24:25], v[64:65], v[20:23]
    buffer_load_dwordx2 v[88:89], v12, s[12:15], s16 offen nt
    s_add_u32 s16, s16, 36864
    v_and_b32_dpp v26, v48, v14 row_newbcast:1 row_mask:0xf bank_mask:0xf
    v_and_b32_dpp v27, v48, v15 row_newbcast:1 row_mask:0xf bank_mask:0xf
    s_waitcnt vmcnt(11)
    s_nop 0
    v_mfma_f32_16x16x16_bf16 v[20:23], v[26:27], v[66:67], v[20:23]
    buffer_load_dwordx2 v[90:91], v12, s[12:15], s16 offen nt
    s_add_u32 s16, s16, 36864
    v_and_b32_dpp v24, v48, v14 row_newbcast:2 row_mask:0xf bank_mask:0xf
    v_and_b32_dpp v25, v48, v15 row_newbcast:2 row_mask:0xf bank_mask:0xf
    s_waitcnt vmcnt(11)
    s_nop 0
    v_mfma_f32_16x16x16_bf16 v[20:23], v[24:25], v[68:69], v[20:23]
    buffer_load_dwordx2 v[92:93], v12, s[12:15], s16 offen nt
    s_add_u32 s16, s16, 36864
    v_and_b32_dpp v26, v48, v14 row_newbcast:3 row_mask:0xf bank_mask:0xf
    v_and_b32_dpp v27, v48, v15 row_newbcast:3 row_mask:0xf bank_mask:0xf
    s_waitcnt vmcnt(11)
    s_nop 0
    v_mfma_f32_16x16x16_bf16 v[20:23], v[26:27], v[70:71], v[20:23]
    buffer_load_dwordx2 v[94:95], v12, s[12:15], s16 offen nt
    s_add_u32 s16, s16, 36864
    v_and_b32_dpp v24, v48, v14 row_newbcast:4 row_mask:0xf bank_mask:0xf
    v_and_b32_dpp v25, v48, v15 row_newbcast:4 row_mask:0xf bank_mask:0xf
    s_waitcnt vmcnt(11)
    s_nop 0
    v_mfma_f32_16x16x16_bf16 v[20:23], v[24:25], v[72:73], v[20:23]
    buffer_load_dwordx2 v[64:65], v12, s[12:15], s16 offen nt
    s_add_u32 s16, s16, 36864
    v_and_b32_dpp v26, v48, v14 row_newbcast:5 row_mask:0xf bank_mask:0xf
    v_and_b32_dpp v27, v48, v15 row_newbcast:5 row_mask:0xf bank_mask:0xf
    s_waitcnt vmcnt(11)
    s_nop 0
    v_mfma_f32_16x16x16_bf16 v[20:23], v[26:27], v[74:75], v[20:23]
    buffer_load_dwordx2 v[66:67], v12, s[12:15], s16 offen nt
    s_add_u32 s16, s16, 36864
    v_and_b32_dpp v24, v48, v14 row_newbcast:6 row_mask:0xf bank_mask:0xf
    v_and_b32_dpp v25, v48, v15 row_newbcast:6 row_mask:0xf bank_mask:0xf
    s_waitcnt vmcnt(11)
    s_nop 0
    v_mfma_f32_16x16x16_bf16 v[20:23], v[24:25], v[76:77], v[20:23]
    buffer_load_dwordx2 v[68:69], v12, s[12:15], s16 offen nt
    s_add_u32 s16, s16, 36864
    v_and_b32_dpp v26, v48, v14 row_newbcast:7 row_mask:0xf bank_mask:0xf
    v_and_b32_dpp v27, v48, v15 row_newbcast:7 row_mask:0xf bank_mask:0xf
    s_waitcnt vmcnt(11)
    s_nop 0
    v_mfma_f32_16x16x16_bf16 v[20:23], v[26:27], v[78:79], v[20:23]
    buffer_load_dwordx2 v[70:71], v12, s[12:15], s16 offen nt
    s_add_u32 s16, s16, 36864
    v_and_b32_dpp v24, v48, v14 row_newbcast:8 row_mask:0xf bank_mask:0xf
    v_and_b32_dpp v25, v48, v15 row_newbcast:8 row_mask:0xf bank_mask:0xf
    s_waitcnt vmcnt(11)
    s_nop 0
    v_mfma_f32_16x16x16_bf16 v[20:23], v[24:25], v[80:81], v[20:23]
    buffer_load_dwordx2 v[72:73], v12, s[12:15], s16 offen nt
    s_add_u32 s16, s16, 36864
    v_and_b32_dpp v26, v48, v14 row_newbcast:9 row_mask:0xf bank_mask:0xf
    v_and_b32_dpp v27, v48, v15 row_newbcast:9 row_mask:0xf bank_mask:0xf
    s_waitcnt vmcnt(11)
    s_nop 0
    v_mfma_f32_16x16x16_bf16 v[20:23], v[26:27], v[82:83], v[20:23]
    buffer_load_dwordx2 v[74:75], v12, s[12:15], s16 offen nt
    s_add_u32 s16, s16, 36864
    v_and_b32_dpp v24, v48, v14 row_newbcast:10 row_mask:0xf bank_mask:0xf
    v_and_b32_dpp v25, v48, v15 row_newbcast:10 row_mask:0xf bank_mask:0xf
    s_waitcnt vmcnt(11)
    s_nop 0
    v_mfma_f32_16x16x16_bf16 v[20:23], v[24:25], v[84:85], v[20:23]
    buffer_load_dwordx2 v[76:77], v12, s[12:15], s16 offen nt
    s_add_u32 s16, s16, 36864
    v_and_b32_dpp v26, v48, v14 row_newbcast:11 row_mask:0xf bank_mask:0xf
    v_and_b32_dpp v27, v48, v15 row_newbcast:11 row_mask:0xf bank_mask:0xf
    s_waitcnt vmcnt(11)
    s_nop 0
    v_mfma_f32_16x16x16_bf16 v[20:23], v[26:27], v[86:87], v[20:23]
    buffer_load_dwordx2 v[78:79], v12, s[12:15], s16 offen nt
    s_add_u32 s16, s16, 36864
    v_and_b32_dpp v24, v48, v14 row_newbcast:12 row_mask:0xf bank_mask:0xf
    v_and_b32_dpp v25, v48, v15 row_newbcast:12 row_mask:0xf bank_mask:0xf
    s_waitcnt vmcnt(11)
    s_nop 0
    v_mfma_f32_16x16x16_bf16 v[20:23], v[24:25], v[88:89], v[20:23]
    buffer_load_dwordx2 v[80:81], v12, s[12:15], s16 offen nt
    s_add_u32 s16, s16, 36864
    v_and_b32_dpp v26, v48, v14 row_newbcast:13 row_mask:0xf bank_mask:0xf
    v_and_b32_dpp v27, v48, v15 row_newbcast:13 row_mask:0xf bank_mask:0xf
    s_waitcnt vmcnt(11)
    s_nop 0
    v_mfma_f32_16x16x16_bf16 v[20:23], v[26:27], v[90:91], v[20:23]
    buffer_load_dwordx2 v[82:83], v12, s[12:15], s16 offen nt
    s_add_u32 s16, s16, 36864
    v_and_b32_dpp v24, v48, v14 row_newbcast:14 row_mask:0xf bank_mask:0xf
    v_and_b32_dpp v25, v48, v15 row_newbcast:14 row_mask:0xf bank_mask:0xf
    s_waitcnt vmcnt(11)
    s_nop 0
    v_mfma_f32_16x16x16_bf16 v[20:23], v[24:25], v[92:93], v[20:23]
    buffer_load_dwordx2 v[84:85], v12, s[12:15], s16 offen nt
    s_add_u32 s16, s16, 36864
    v_and_b32_dpp v26, v48, v14 row_newbcast:15 row_mask:0xf bank_mask:0xf
    v_and_b32_dpp v27, v48, v15 row_newbcast:15 row_mask:0xf bank_mask:0xf
    s_waitcnt vmcnt(11)
    s_nop 0
    v_mfma_f32_16x16x16_bf16 v[20:23], v[26:27], v[94:95], v[20:23]
    buffer_load_dwordx2 v[86:87], v12, s[12:15], s16 offen nt
    s_add_u32 s16, s16, 36864
    v_mov_b32 v48, v49
    v_mov_b32 v49, v50
    v_mov_b32 v50, v51
    v_mov_b32 v51, v52
    v_mov_b32 v52, v53
    v_mov_b32 v53, v54
    v_mov_b32 v54, v55
    v_mov_b32 v55, v56
    s_sub_u32 s31, s31, 1
    s_cmp_lg_u32 s31, 0
    s_cbranch_scc1 L_f1
    s_mov_b32 s12, s52
    s_mov_b32 s13, s53
    s_mov_b32 s14, 0x510000
    s_mov_b32 s15, 0x20000
    s_waitcnt vmcnt(0)
    s_mul_i32 s16, s17, 73728
    buffer_load_dwordx2 v[64:65], v13, s[12:15], s16 offen offset:0 nt
    buffer_load_dwordx2 v[66:67], v13, s[12:15], s16 offen offset:128 nt
    buffer_load_dwordx2 v[68:69], v13, s[12:15], s16 offen offset:256 nt
    buffer_load_dwordx2 v[70:71], v13, s[12:15], s16 offen offset:384 nt
    buffer_load_dwordx2 v[72:73], v13, s[12:15], s16 offen offset:512 nt
    buffer_load_dwordx2 v[74:75], v13, s[12:15], s16 offen offset:640 nt
    buffer_load_dwordx2 v[76:77], v13, s[12:15], s16 offen offset:768 nt
    buffer_load_dwordx2 v[78:79], v13, s[12:15], s16 offen offset:896 nt
    buffer_load_dwordx2 v[80:81], v13, s[12:15], s16 offen offset:1024 nt
    s_add_u32 s16, s16, 4608
    buffer_load_dwordx2 v[82:83], v13, s[12:15], s16 offen offset:0 nt
    buffer_load_dwordx2 v[84:85], v13, s[12:15], s16 offen offset:128 nt
    buffer_load_dwordx2 v[86:87], v13, s[12:15], s16 offen offset:256 nt
    v_lshlrev_b32 v28, 16, v60
    v_and_b32 v29, 0xffff0000, v60
    v_lshlrev_b32 v30, 16, v61
    v_and_b32 v31, 0xffff0000, v61
    s_mov_b32 s18, 0x3d372713
    s_mov_b32 s19, 0xc0135761
    v_cvt_pk_bf16_f32 v20, v20, v20
    v_and_b32 v20, 0xffff0000, v20
    v_add_f32 v20, v20, v28
    v_cvt_pk_bf16_f32 v20, v20, v20
    v_and_b32 v20, 0xffff0000, v20
    v_mul_f32 v28, v20, v20
    v_mul_f32 v28, v28, v20
    v_fma_f32 v28, v28, s18, v20
    v_mul_f32 v28, s19, v28
    v_exp_f32 v28, v28
    s_nop 0
    v_add_f32 v28, 1.0, v28
    v_rcp_f32 v28, v28
    s_nop 0
    v_mul_f32 v20, v20, v28
    v_cvt_pk_bf16_f32 v21, v21, v21
    v_and_b32 v21, 0xffff0000, v21
    v_add_f32 v21, v21, v29
    v_cvt_pk_bf16_f32 v21, v21, v21
    v_and_b32 v21, 0xffff0000, v21
    v_mul_f32 v29, v21, v21
    v_mul_f32 v29, v29, v21
    v_fma_f32 v29, v29, s18, v21
    v_mul_f32 v29, s19, v29
    v_exp_f32 v29, v29
    s_nop 0
    v_add_f32 v29, 1.0, v29
    v_rcp_f32 v29, v29
    s_nop 0
    v_mul_f32 v21, v21, v29
    v_cvt_pk_bf16_f32 v22, v22, v22
    v_and_b32 v22, 0xffff0000, v22
    v_add_f32 v22, v22, v30
    v_cvt_pk_bf16_f32 v22, v22, v22
    v_and_b32 v22, 0xffff0000, v22
    v_mul_f32 v30, v22, v22
    v_mul_f32 v30, v30, v22
    v_fma_f32 v30, v30, s18, v22
    v_mul_f32 v30, s19, v30
    v_exp_f32 v30, v30
    s_nop 0
    v_add_f32 v30, 1.0, v30
    v_rcp_f32 v30, v30
    s_nop 0
    v_mul_f32 v22, v22, v30
    v_cvt_pk_bf16_f32 v23, v23, v23
    v_and_b32 v23, 0xffff0000, v23
    v_add_f32 v23, v23, v31
    v_cvt_pk_bf16_f32 v23, v23, v23
    v_and_b32 v23, 0xffff0000, v23
    v_mul_f32 v31, v23, v23
    v_mul_f32 v31, v31, v23
    v_fma_f32 v31, v31, s18, v23
    v_mul_f32 v31, s19, v31
    v_exp_f32 v31, v31
    s_nop 0
    v_add_f32 v31, 1.0, v31
    v_rcp_f32 v31, v31
    s_nop 0
    v_mul_f32 v23, v23, v31
    v_cvt_pk_bf16_f32 v28, v20, v21
    v_cvt_pk_bf16_f32 v29, v22, v23
    s_mov_b64 exec, 0xffff
    ds_write_b64 v9, v[28:29]
    s_mov_b64 exec, -1
    s_waitcnt lgkmcnt(0)
    s_mul_i32 s19, s17, 73728
    s_add_u32 s19, s19, 73728
    s_mov_b32 s18, 5308416
    s_mov_b32 s31, 8
L_f2:
    ds_read_u16 v28, v11 offset:0
    s_waitcnt lgkmcnt(0)
    v_lshl_or_b32 v28, v28, 16, v28
    v_and_b32 v24, v28, v14
    v_and_b32 v25, v28, v15
    s_waitcnt vmcnt(11)
    s_nop 0
    v_mfma_f32_16x16x16_bf16 v[104:107], v[24:25], v[64:65], v[104:107]
    buffer_load_dwordx2 v[88:89], v13, s[12:15], s16 offen offset:384 nt
    s_waitcnt vmcnt(11)
    v_mfma_f32_16x16x16_bf16 v[108:111], v[24:25], v[66:67], v[108:111]
    buffer_load_dwordx2 v[90:91], v13, s[12:15], s16 offen offset:512 nt
    s_waitcnt vmcnt(11)
    v_mfma_f32_16x16x16_bf16 v[112:115], v[24:25], v[68:69], v[112:115]
    buffer_load_dwordx2 v[92:93], v13, s[12:15], s16 offen offset:640 nt
    s_waitcnt vmcnt(11)
    v_mfma_f32_16x16x16_bf16 v[116:119], v[24:25], v[70:71], v[116:119]
    buffer_load_dwordx2 v[94:95], v13, s[12:15], s16 offen offset:768 nt
    s_waitcnt vmcnt(11)
    v_mfma_f32_16x16x16_bf16 v[120:123], v[24:25], v[72:73], v[120:123]
    buffer_load_dwordx2 v[96:97], v13, s[12:15], s16 offen offset:896 nt
    s_waitcnt vmcnt(11)
    v_mfma_f32_16x16x16_bf16 v[124:127], v[24:25], v[74:75], v[124:127]
    buffer_load_dwordx2 v[98:99], v13, s[12:15], s16 offen offset:1024 nt
    s_add_u32 s16, s16, 4608
    s_waitcnt vmcnt(11)
    v_mfma_f32_16x16x16_bf16 v[128:131], v[24:25], v[76:77], v[128:131]
    s_cmp_lt_u32 s16, s19
    s_cselect_b32 s14, s18, 0
    buffer_load_dwordx2 v[64:65], v13, s[12:15], s16 offen offset:0 nt
    s_waitcnt vmcnt(11)
    v_mfma_f32_16x16x16_bf16 v[132:135], v[24:25], v[78:79], v[132:135]
    buffer_load_dwordx2 v[66:67], v13, s[12:15], s16 offen offset:128 nt
    s_waitcnt vmcnt(11)
    v_mfma_f32_16x16x16_bf16 v[136:139], v[24:25], v[80:81], v[136:139]
    buffer_load_dwordx2 v[68:69], v13, s[12:15], s16 offen offset:256 nt
    ds_read_u16 v28, v11 offset:8
    s_waitcnt lgkmcnt(0)
    v_lshl_or_b32 v28, v28, 16, v28
    v_and_b32 v24, v28, v14
    v_and_b32 v25, v28, v15
    s_waitcnt vmcnt(11)
    s_nop 0
    v_mfma_f32_16x16x16_bf16 v[104:107], v[24:25], v[82:83], v[104:107]
    buffer_load_dwordx2 v[70:71], v13, s[12:15], s16 offen offset:384 nt
    s_waitcnt vmcnt(11)
    v_mfma_f32_16x16x16_bf16 v[108:111], v[24:25], v[84:85], v[108:111]
    buffer_load_dwordx2 v[72:73], v13, s[12:15], s16 offen offset:512 nt
    s_waitcnt vmcnt(11)
    v_mfma_f32_16x16x16_bf16 v[112:115], v[24:25], v[86:87], v[112:115]
    buffer_load_dwordx2 v[74:75], v13, s[12:15], s16 offen offset:640 nt
    s_waitcnt vmcnt(11)
    v_mfma_f32_16x16x16_bf16 v[116:119], v[24:25], v[88:89], v[116:119]
    buffer_load_dwordx2 v[76:77], v13, s[12:15], s16 offen offset:768 nt
    s_waitcnt vmcnt(11)
    v_mfma_f32_16x16x16_bf16 v[120:123], v[24:25], v[90:91], v[120:123]
    buffer_load_dwordx2 v[78:79], v13, s[12:15], s16 offen offset:896 nt
    s_waitcnt vmcnt(11)
    v_mfma_f32_16x16x16_bf16 v[124:127], v[24:25], v[92:93], v[124:127]
    buffer_load_dwordx2 v[80:81], v13, s[12:15], s16 offen offset:1024 nt
    s_add_u32 s16, s16, 4608
    s_waitcnt vmcnt(11)
    v_mfma_f32_16x16x16_bf16 v[128:131], v[24:25], v[94:95], v[128:131]
    s_cmp_lt_u32 s16, s19
    s_cselect_b32 s14, s18, 0
    buffer_load_dwordx2 v[82:83], v13, s[12:15], s16 offen offset:0 nt
    s_waitcnt vmcnt(11)
    v_mfma_f32_16x16x16_bf16 v[132:135], v[24:25], v[96:97], v[132:135]
    buffer_load_dwordx2 v[84:85], v13, s[12:15], s16 offen offset:128 nt
    s_waitcnt vmcnt(11)
    v_mfma_f32_16x16x16_bf16 v[136:139], v[24:25], v[98:99], v[136:139]
    buffer_load_dwordx2 v[86:87], v13, s[12:15], s16 offen offset:256 nt
    v_add_u32 v11, 16, v11
    s_sub_u32 s31, s31, 1
    s_cmp_lg_u32 s31, 0
    s_cbranch_scc1 L_f2
L_fy:
    s_mov_b64 exec, 0xffff
    ds_write_b128 v10, v[104:107] offset:0
    ds_write_b128 v10, v[108:111] offset:256
    ds_write_b128 v10, v[112:115] offset:512
    ds_write_b128 v10, v[116:119] offset:768
    ds_write_b128 v10, v[120:123] offset:1024
    ds_write_b128 v10, v[124:127] offset:1280
    ds_write_b128 v10, v[128:131] offset:1536
    ds_write_b128 v10, v[132:135] offset:1792
    ds_write_b128 v10, v[136:139] offset:2048
    s_mov_b64 exec, -1
    s_waitcnt vmcnt(0) lgkmcnt(0)
L_s1:
    v_mov_b32 v4, 154816
    v_mov_b32 v5, 1
    s_mov_b64 exec, 1
    ds_add_u32 v4, v5 offset:12
    s_mov_b64 exec, -1
    s_branch L_setup
L_sdone:
    s_mov_b32 exec_hi, -1
    s_waitcnt vmcnt(0)
    v_mov_b32 v4, 154816
    s_cmp_eq_u32 s3, 0
    s_cbranch_scc1 L_sw0
    v_mov_b32 v5, 1
    ds_write_b32 v4, v5 offset:8
    s_branch L_setup
L_sw0:
    s_mov_b32 s30, 65536
L_sw:
    ds_read_b32 v5, v4 offset:8
    s_waitcnt lgkmcnt(0)
    v_cmp_eq_u32 vcc, 0, v5
    s_nop 1
    s_cbranch_vccz L_sw_ok
    s_sub_u32 s30, s30, 1
    s_cmp_eq_u32 s30, 0
    s_cbranch_scc1 L_sw_ok
    s_sleep 4
    s_branch L_sw
L_sw_ok:
    s_mov_b32 s8, s60
    s_mov_b32 s9, s61
    s_mov_b32 s10, 0x68000
    s_mov_b32 s11, 0x20000
    s_mov_b32 s35, 1
    s_branch L_merge
L_setup:
    v_mov_b32 v4, 154816
    s_mov_b32 s30, 65536
L_s1w:
    ds_read_b32 v5, v4 offset:12
    s_waitcnt lgkmcnt(0)
    v_cmp_gt_u32 vcc, 6, v5
    s_nop 1
    s_cbranch_vccz L_s1w_ok
    s_sub_u32 s30, s30, 1
    s_cmp_eq_u32 s30, 0
    s_cbranch_scc1 L_s1w_ok
    s_sleep 16
    s_branch L_s1w
L_s1w_ok:
    s_mov_b32 s8, s60
    s_mov_b32 s9, s61
    s_mov_b32 s10, 0x68000
    s_mov_b32 s11, 0x20000
    v_mov_b32 v4, 154816
    ds_read_b32 v202, v4
    v_mov_b32 v203, 0
    s_lshl_b32 s33, s20, 7
    s_lshl_b32 s28, s20, 6
    v_and_b32 v200, 7, v1
    v_lshrrev_b32 v201, 3, v1
    v_mul_u32_u24 v201, 2304, v201
    v_lshl_add_u32 v201, v200, 4, v201
    v_lshl_add_u32 v200, v200, 2, v3
    v_lshlrev_b32 v200, 1, v200
    v_add_u32 v199, 18432, v201
    s_waitcnt lgkmcnt(0)
    s_sub_u32 s35, s3, 2
    s_cmp_ge_u32 s35, 3
    s_cbranch_scc1 L_tail
    s_mul_i32 s17, s35, 48
    v_add_u32 v4, s17, v1
    v_min_u32 v5, 143, v4
    v_lshlrev_b32 v6, 4, v5
    v_add_u32 v5, 147904, v6
    ds_read_b128 v[8:11], v5 offset:0
    ds_read_b128 v[12:15], v5 offset:2304
    ds_read_b128 v[16:19], v5 offset:4608
    v_mov_b32 v7, 0x7fffff00
    v_cmp_gt_u32 vcc, 48, v1
    s_nop 1
    v_cndmask_b32 v6, v7, v6, vcc
    s_mul_i32 s16, s20, 2304
    s_add_u32 s16, s16, 286720
    s_waitcnt lgkmcnt(0)
    v_add_f32 v8, v8, v12
    v_add_f32 v9, v9, v13
    v_add_f32 v10, v10, v14
    v_add_f32 v11, v11, v15
    v_add_f32 v8, v8, v16
    v_add_f32 v9, v9, v17
    v_add_f32 v10, v10, v18
    v_add_f32 v11, v11, v19
    v_add_u32 v8, 8, v8
    v_bfi_b32 v8, 15, v202, v8
    v_add_u32 v9, 8, v9
    v_bfi_b32 v9, 15, v202, v9
    v_add_u32 v10, 8, v10
    v_bfi_b32 v10, 15, v202, v10
    v_add_u32 v11, 8, v11
    v_bfi_b32 v11, 15, v202, v11
    buffer_store_dwordx4 v[8:11], v6, s[8:11], s16 offen sc1
    s_cmp_lg_u32 s3, 2
    s_cbranch_scc1 L_tail
    s_cmp_ge_u32 s20, 18
    s_cbranch_scc1 L_tail
    s_mov_b32 s12, s36
    s_mov_b32 s13, s37
    s_mov_b32 s14, 0x480
    s_mov_b32 s15, 0x20000
    buffer_load_ushort v188, v200, s[12:15], s28 offen
    s_mov_b32 s12, s54
    s_mov_b32 s13, s55
    s_mov_b32 s14, 0x480
    s_mov_b32 s15, 0x20000
    buffer_load_ushort v192, v200, s[12:15], s28 offen
    s_waitcnt vmcnt(0)
    v_lshlrev_b32 v188, 16, v188
    v_lshlrev_b32 v192, 16, v192
    v_mov_b32 v6, 0x7fffff00
    v_cmp_gt_u32 vcc, 8, v2
    s_nop 1
    v_cndmask_b32 v200, v6, v200, vcc
    s_add_u32 s16, s33, 286720
    s_mov_b32 s30, 65536
L_hf:
    s_add_u32 s17, s16, 36864
    buffer_load_dwordx4 v[20:23], v201, s[8:11], s16 offen sc1
    buffer_load_dwordx4 v[24:27], v199, s[8:11], s16 offen sc1
    buffer_load_dwordx4 v[28:31], v201, s[8:11], s17 offen sc1
    buffer_load_dwordx4 v[32:35], v199, s[8:11], s17 offen sc1
    s_waitcnt vmcnt(0)
    v_xor_b32 v40, v20, v202
    v_xor_b32 v41, v21, v202
    v_xor_b32 v42, v22, v202
    v_or3_b32 v40, v40, v41, v42
    v_xor_b32 v41, v23, v202
    v_xor_b32 v42, v24, v202
    v_or3_b32 v40, v40, v41, v42
    v_xor_b32 v41, v25, v202
    v_xor_b32 v42, v26, v202
    v_or3_b32 v40, v40, v41, v42
    v_xor_b32 v41, v27, v202
    v_xor_b32 v42, v28, v202
    v_or3_b32 v40, v40, v41, v42
    v_xor_b32 v41, v29, v202
    v_xor_b32 v42, v30, v202
    v_or3_b32 v40, v40, v41, v42
    v_xor_b32 v41, v31, v202
    v_xor_b32 v42, v32, v202
    v_or3_b32 v40, v40, v41, v42
    v_xor_b32 v41, v33, v202
    v_xor_b32 v42, v34, v202
    v_or3_b32 v40, v40, v41, v42
    v_xor_b32 v41, v35, v202
    v_or_b32 v40, v40, v41
    v_and_b32 v40, 15, v40
    v_cmp_ne_u32 vcc, 0, v40
    s_nop 1
    s_cbranch_vccz L_hf_ok
    s_sub_u32 s30, s30, 1
    s_cmp_eq_u32 s30, 0
    s_cbranch_scc1 L_hf_ok
    s_sleep 64
    s_branch L_hf
L_hf_ok:
    v_and_b32 v20, -16, v20
    v_and_b32 v21, -16, v21
    v_and_b32 v22, -16, v22
    v_and_b32 v23, -16, v23
    v_and_b32 v24, -16, v24
    v_and_b32 v25, -16, v25
    v_and_b32 v26, -16, v26
    v_and_b32 v27, -16, v27
    v_and_b32 v28, -16, v28
    v_and_b32 v29, -16, v29
    v_and_b32 v30, -16, v30
    v_and_b32 v31, -16, v31
    v_and_b32 v32, -16, v32
    v_and_b32 v33, -16, v33
    v_and_b32 v34, -16, v34
    v_and_b32 v35, -16, v35
    v_add_f32 v20, v20, v28
    v_add_f32 v21, v21, v29
    v_add_f32 v22, v22, v30
    v_add_f32 v23, v23, v31
    v_add_f32 v24, v24, v32
    v_add_f32 v25, v25, v33
    v_add_f32 v26, v26, v34
    v_add_f32 v27, v27, v35
    v_add_f32 v48, v20, v24
    v_add_f32 v49, v21, v25
    v_add_f32 v50, v22, v26
    v_add_f32 v51, v23, v27
    v_add_f32_dpp v48, v48, v48 row_ror:8 row_mask:0xf bank_mask:0xf
    v_add_f32_dpp v49, v49, v49 row_ror:8 row_mask:0xf bank_mask:0xf
    v_add_f32_dpp v50, v50, v50 row_ror:8 row_mask:0xf bank_mask:0xf
    v_add_f32_dpp v51, v51, v51 row_ror:8 row_mask:0xf bank_mask:0xf
    v_permlane16_swap_b32 v48, v49
    s_nop 0
    v_permlane16_swap_b32 v50, v51
    v_add_f32 v48, v48, v49
    v_add_f32 v50, v50, v51
    s_nop 1
    v_permlane32_swap_b32 v48, v50
    v_add_f32 v48, v48, v50
    v_cvt_pk_bf16_f32 v48, v48, v48
    v_and_b32 v48, 0xffff0000, v48
    v_add_f32 v192, v48, v192
    v_cvt_pk_bf16_f32 v192, v192, v192
    v_and_b32 v192, 0xffff0000, v192
L_tail:
    s_lshl_b32 s18, s3, 7
    v_lshrrev_b32 v14, 2, v2
    v_lshl_add_u32 v14, v3, 3, v14
    v_mul_u32_u24 v14, 1152, v14
    v_and_b32 v15, 3, v2
    v_lshl_add_u32 v14, v15, 3, v14
    s_and_b32 s17, s3, 3
    s_lshl_b32 s17, s17, 5
    s_add_u32 s17, s17, 1024
    v_add_u32 v16, s17, v14
    v_add_u32 v17, 73728, v16
    v_add_u32 v14, s18, v14
    v_add_u32 v15, 73728, v14
    ds_read_b64_tr_b16 v[64:65], v14 offset:0
    ds_read_b64_tr_b16 v[66:67], v14 offset:4608
    ds_read_b64_tr_b16 v[68:69], v14 offset:36864
    ds_read_b64_tr_b16 v[70:71], v14 offset:41472
    ds_read_b64_tr_b16 v[72:73], v15 offset:0
    ds_read_b64_tr_b16 v[74:75], v15 offset:4608
    ds_read_b64_tr_b16 v[76:77], v15 offset:36864
    ds_read_b64_tr_b16 v[78:79], v15 offset:41472
    s_waitcnt lgkmcnt(0)
    ds_read_b64_tr_b16 v[80:81], v14 offset:32
    ds_read_b64_tr_b16 v[82:83], v14 offset:4640
    ds_read_b64_tr_b16 v[84:85], v14 offset:36896
    ds_read_b64_tr_b16 v[86:87], v14 offset:41504
    ds_read_b64_tr_b16 v[88:89], v15 offset:32
    ds_read_b64_tr_b16 v[90:91], v15 offset:4640
    ds_read_b64_tr_b16 v[92:93], v15 offset:36896
    ds_read_b64_tr_b16 v[94:95], v15 offset:41504
    s_waitcnt lgkmcnt(0)
    ds_read_b64_tr_b16 v[96:97], v14 offset:64
    ds_read_b64_tr_b16 v[98:99], v14 offset:4672
    ds_read_b64_tr_b16 v[100:101], v14 offset:36928
    ds_read_b64_tr_b16 v[102:103], v14 offset:41536
    ds_read_b64_tr_b16 v[104:105], v15 offset:64
    ds_read_b64_tr_b16 v[106:107], v15 offset:4672
    ds_read_b64_tr_b16 v[108:109], v15 offset:36928
    ds_read_b64_tr_b16 v[110:111], v15 offset:41536
    s_waitcnt lgkmcnt(0)
    ds_read_b64_tr_b16 v[112:113], v14 offset:96
    ds_read_b64_tr_b16 v[114:115], v14 offset:4704
    ds_read_b64_tr_b16 v[116:117], v14 offset:36960
    ds_read_b64_tr_b16 v[118:119], v14 offset:41568
    ds_read_b64_tr_b16 v[120:121], v15 offset:96
    ds_read_b64_tr_b16 v[122:123], v15 offset:4704
    ds_read_b64_tr_b16 v[124:125], v15 offset:36960
    ds_read_b64_tr_b16 v[126:127], v15 offset:41568
    s_waitcnt lgkmcnt(0)
    ds_read_b64_tr_b16 v[128:129], v16 offset:0
    ds_read_b64_tr_b16 v[130:131], v16 offset:4608
    ds_read_b64_tr_b16 v[132:133], v16 offset:36864
    ds_read_b64_tr_b16 v[134:135], v16 offset:41472
    ds_read_b64_tr_b16 v[136:137], v17 offset:0
    ds_read_b64_tr_b16 v[138:139], v17 offset:4608
    ds_read_b64_tr_b16 v[140:141], v17 offset:36864
    ds_read_b64_tr_b16 v[142:143], v17 offset:41472
    s_waitcnt lgkmcnt(0)
    s_mul_i32 s31, s20, 2304
    s_add_u32 s31, s31, 212992
    s_lshl_b32 s32, s3, 8
    v_lshl_add_u32 v6, v1, 2, s32
    s_lshl_b32 s32, s3, 6
    s_add_u32 s32, s32, 2048
    v_lshl_add_u32 v7, v1, 2, s32
    s_cmp_lt_u32 s3, 4
    s_cselect_b32 s18, 16, 0
    v_mov_b32 v4, 0x7fffff00
    v_cmp_gt_u32 vcc, s18, v1
    s_nop 1
    v_cndmask_b32 v7, v4, v7, vcc
    s_lshl_b32 s16, s20, 11
    s_add_u32 s16, s16, 0
    s_lshl_b32 s18, s20, 7
    s_add_u32 s18, s18, 65536
    v_and_b32 v12, 7, v2
    v_lshlrev_b32 v12, 8, v12
    v_lshl_add_u32 v12, v3, 4, v12
    v_and_b32 v13, 1, v3
    v_lshlrev_b32 v13, 4, v13
    v_lshlrev_b32 v5, 4, v1
    v_add_u32 v5, 154880, v5
    s_cmp_lg_u32 s3, 7
    s_cbranch_scc1 L_wait1
    s_mov_b32 s30, 65536
    v_min_u32 v4, 6, v1
    v_lshlrev_b32 v4, 2, v4
L_pre:
    buffer_load_dword v8, v4, s[8:11], s18 offen sc1
    s_waitcnt vmcnt(0)
    v_cmp_ne_u32 vcc, -1, v8
    s_nop 1
    s_cbranch_vccnz L_pre_ok
    s_sub_u32 s30, s30, 1
    s_cmp_eq_u32 s30, 0
    s_cbranch_scc1 L_pre_ok
    s_sleep 32
    s_branch L_pre
L_pre_ok:
    buffer_load_dwordx4 v[16:19], v12, s[8:11], s16 offen offset:0 sc1
    buffer_load_dwordx4 v[20:23], v12, s[8:11], s16 offen offset:64 sc1
    buffer_load_dwordx4 v[24:27], v12, s[8:11], s16 offen offset:128 sc1
    buffer_load_dwordx4 v[28:31], v12, s[8:11], s16 offen offset:192 sc1
    buffer_load_dwordx4 v[32:35], v13, s[8:11], s18 offen sc1
    buffer_load_dwordx4 v[36:39], v13, s[8:11], s18 offen offset:64 sc1
    s_mov_b32 s30, 65536
L_h1:
    buffer_load_dwordx4 v[204:207], v12, s[8:11], s16 offen offset:0 sc1
    buffer_load_dwordx4 v[208:211], v12, s[8:11], s16 offen offset:64 sc1
    buffer_load_dwordx4 v[212:215], v12, s[8:11], s16 offen offset:128 sc1
    buffer_load_dwordx4 v[216:219], v12, s[8:11], s16 offen offset:192 sc1
    buffer_load_dwordx4 v[220:223], v13, s[8:11], s18 offen sc1
    buffer_load_dwordx4 v[224:227], v13, s[8:11], s18 offen offset:64 sc1
    s_waitcnt vmcnt(6)
    v_max3_u32 v40, v16, v17, v18
    v_max3_u32 v41, v28, v29, v30
    v_max3_u32 v40, v40, v19, v20
    v_max3_u32 v41, v41, v31, v32
    v_max3_u32 v40, v40, v21, v22
    v_max3_u32 v41, v41, v33, v34
    v_max3_u32 v40, v40, v23, v24
    v_max3_u32 v41, v41, v35, v36
    v_max3_u32 v40, v40, v25, v26
    v_max3_u32 v41, v41, v37, v38
    v_max3_u32 v40, v40, v27, v39
    v_max_u32 v40, v40, v41
    v_cmp_eq_u32 vcc, -1, v40
    s_nop 1
    s_cbranch_vccz L_h1_ok0
    buffer_load_dwordx4 v[16:19], v12, s[8:11], s16 offen offset:0 sc1
    buffer_load_dwordx4 v[20:23], v12, s[8:11], s16 offen offset:64 sc1
    buffer_load_dwordx4 v[24:27], v12, s[8:11], s16 offen offset:128 sc1
    buffer_load_dwordx4 v[28:31], v12, s[8:11], s16 offen offset:192 sc1
    buffer_load_dwordx4 v[32:35], v13, s[8:11], s18 offen sc1
    buffer_load_dwordx4 v[36:39], v13, s[8:11], s18 offen offset:64 sc1
    s_waitcnt vmcnt(6)
    v_max3_u32 v40, v204, v205, v206
    v_max3_u32 v41, v216, v217, v218
    v_max3_u32 v40, v40, v207, v208
    v_max3_u32 v41, v41, v219, v220
    v_max3_u32 v40, v40, v209, v210
    v_max3_u32 v41, v41, v221, v222
    v_max3_u32 v40, v40, v211, v212
    v_max3_u32 v41, v41, v223, v224
    v_max3_u32 v40, v40, v213, v214
    v_max3_u32 v41, v41, v225, v226
    v_max3_u32 v40, v40, v215, v227
    v_max_u32 v40, v40, v41
    v_cmp_eq_u32 vcc, -1, v40
    s_nop 1
    s_cbranch_vccz L_h1_ok1
    s_sub_u32 s30, s30, 1
    s_cmp_lg_u32 s30, 0
    s_cbranch_scc1 L_h1
L_h1_ok1:
    ds_write_b128 v5, v[204:207] offset:0
    ds_write_b128 v5, v[208:211] offset:1024
    ds_write_b128 v5, v[212:215] offset:2048
    ds_write_b128 v5, v[216:219] offset:3072
    ds_write_b128 v5, v[220:223] offset:4096
    ds_write_b128 v5, v[224:227] offset:5120
    s_branch L_h1_done
L_h1_ok0:
    ds_write_b128 v5, v[16:19] offset:0
    ds_write_b128 v5, v[20:23] offset:1024
    ds_write_b128 v5, v[24:27] offset:2048
    ds_write_b128 v5, v[28:31] offset:3072
    ds_write_b128 v5, v[32:35] offset:4096
    ds_write_b128 v5, v[36:39] offset:5120
L_h1_done:
    s_waitcnt lgkmcnt(0)
L_wait1:
    s_barrier
    s_waitcnt vmcnt(0)
    ds_read_b128 v[16:19], v5 offset:0
    ds_read_b128 v[32:35], v5 offset:4096
    ds_read_b128 v[36:39], v5 offset:5120
    ds_read_b128 v[20:23], v5 offset:1024
    ds_read_b128 v[24:27], v5 offset:2048
    ds_read_b128 v[28:31], v5 offset:3072
    s_waitcnt lgkmcnt(5)
    v_mfma_f32_16x16x32_bf16 v[160:163], v[16:19], v[64:67], 0
    v_mfma_f32_16x16x32_bf16 v[164:167], v[16:19], v[80:83], 0
    s_waitcnt lgkmcnt(3)
    v_mfma_f32_16x16x32_bf16 v[168:171], v[16:19], v[96:99], 0
    v_max3_f32 v40, v32, v33, v34
    v_max_f32 v40, v40, v35
    v_mfma_f32_16x16x32_bf16 v[172:175], v[16:19], v[112:115], 0
    v_mov_b32 v41, v40
    s_nop 1
    v_permlane16_swap_b32 v41, v40
    v_max_f32 v40, v41, v40
    v_mfma_f32_16x16x32_bf16 v[176:179], v[16:19], v[128:131], 0
    s_waitcnt lgkmcnt(2)
    v_mfma_f32_16x16x32_bf16 v[160:163], v[20:23], v[68:71], v[160:163]
    v_sub_f32 v32, v32, v40
    v_sub_f32 v33, v33, v40
    v_sub_f32 v34, v34, v40
    v_sub_f32 v35, v35, v40
    v_mfma_f32_16x16x32_bf16 v[164:167], v[20:23], v[84:87], v[164:167]
    v_mfma_f32_16x16x32_bf16 v[168:171], v[20:23], v[100:103], v[168:171]
    v_mul_f32 v32, s24, v32
    v_mul_f32 v33, s24, v33
    v_mul_f32 v34, s24, v34
    v_mul_f32 v35, s24, v35
    v_mfma_f32_16x16x32_bf16 v[172:175], v[20:23], v[116:119], v[172:175]
    v_exp_f32 v32, v32
    v_exp_f32 v33, v33
    v_exp_f32 v34, v34
    v_exp_f32 v35, v35
    v_mfma_f32_16x16x32_bf16 v[176:179], v[20:23], v[132:135], v[176:179]
    s_waitcnt lgkmcnt(1)
    v_mfma_f32_16x16x32_bf16 v[160:163], v[24:27], v[72:75], v[160:163]
    v_mul_f32 v32, v32, v36
    v_mul_f32 v33, v33, v37
    v_mul_f32 v34, v34, v38
    v_mul_f32 v35, v35, v39
    v_mfma_f32_16x16x32_bf16 v[164:167], v[24:27], v[88:91], v[164:167]
    v_mfma_f32_16x16x32_bf16 v[168:171], v[24:27], v[104:107], v[168:171]
    v_add_f32 v40, v32, v33
    v_add_f32 v41, v34, v35
    v_add_f32 v40, v40, v41
    v_mfma_f32_16x16x32_bf16 v[172:175], v[24:27], v[120:123], v[172:175]
    v_mov_b32 v41, v40
    s_nop 1
    v_permlane16_swap_b32 v41, v40
    v_add_f32 v40, v41, v40
    v_mfma_f32_16x16x32_bf16 v[176:179], v[24:27], v[136:139], v[176:179]
    s_waitcnt lgkmcnt(0)
    v_mfma_f32_16x16x32_bf16 v[160:163], v[28:31], v[76:79], v[160:163]
    v_rcp_f32 v40, v40
    v_mfma_f32_16x16x32_bf16 v[164:167], v[28:31], v[92:95], v[164:167]
    v_mul_f32 v32, v32, v40
    v_mul_f32 v33, v33, v40
    v_mul_f32 v34, v34, v40
    v_mul_f32 v35, v35, v40
    v_mfma_f32_16x16x32_bf16 v[168:171], v[28:31], v[108:111], v[168:171]
    v_mfma_f32_16x16x32_bf16 v[172:175], v[28:31], v[124:127], v[172:175]
    v_mfma_f32_16x16x32_bf16 v[176:179], v[28:31], v[140:143], v[176:179]
    v_mul_f32 v42, v32, v160
    v_fmac_f32 v42, v33, v161
    v_fmac_f32 v42, v34, v162
    v_fmac_f32 v42, v35, v163
    v_mul_f32 v43, v32, v164
    v_fmac_f32 v43, v33, v165
    v_fmac_f32 v43, v34, v166
    v_fmac_f32 v43, v35, v167
    v_mul_f32 v44, v32, v168
    v_fmac_f32 v44, v33, v169
    v_fmac_f32 v44, v34, v170
    v_fmac_f32 v44, v35, v171
    v_mul_f32 v45, v32, v172
    v_fmac_f32 v45, v33, v173
    v_fmac_f32 v45, v34, v174
    v_fmac_f32 v45, v35, v175
    v_mul_f32 v46, v32, v176
    v_fmac_f32 v46, v33, v177
    v_fmac_f32 v46, v34, v178
    v_fmac_f32 v46, v35, v179
    v_cmp_gt_u32 vcc, 32, v1
    v_mov_b32 v47, v46
    s_nop 0
    v_cndmask_b32 v42, v44, v42, vcc
    v_cndmask_b32 v43, v45, v43, vcc
    v_permlane16_swap_b32 v47, v46
    s_nop 0
    v_permlane16_swap_b32 v42, v43
    v_add_f32 v46, v46, v47
    v_add_f32 v42, v42, v43
    v_add_u32 v42, 8, v42
    v_bfi_b32 v42, 15, v202, v42
    v_add_u32 v46, 8, v46
    v_bfi_b32 v46, 15, v202, v46
    buffer_store_dword v42, v6, s[8:11], s31 offen sc1
    buffer_store_dword v46, v7, s[8:11], s31 offen sc1
    s_cmp_lg_u32 s3, 2
    s_cbranch_scc1 L_end
    s_cmp_ge_u32 s20, 18
    s_cbranch_scc1 L_end
    s_mov_b32 s12, s56
    s_mov_b32 s13, s57
    s_mov_b32 s14, 0x480
    s_mov_b32 s15, 0x20000
    s_add_u32 s16, s33, 212992
    s_add_u32 s17, s16, 36864
    buffer_load_dwordx4 v[64:67], v201, s[8:11], s16 offen sc1
    buffer_load_dwordx4 v[68:71], v199, s[8:11], s16 offen sc1
    buffer_load_dwordx4 v[72:75], v201, s[8:11], s17 offen sc1
    buffer_load_dwordx4 v[76:79], v199, s[8:11], s17 offen sc1
    s_mov_b32 s30, 65536
L_h2:
    s_add_u32 s17, s16, 36864
    buffer_load_dwordx4 v[80:83], v201, s[8:11], s16 offen sc1
    buffer_load_dwordx4 v[84:87], v199, s[8:11], s16 offen sc1
    buffer_load_dwordx4 v[88:91], v201, s[8:11], s17 offen sc1
    buffer_load_dwordx4 v[92:95], v199, s[8:11], s17 offen sc1
    s_waitcnt vmcnt(4)
    v_xor_b32 v40, v64, v202
    v_xor_b32 v41, v65, v202
    v_xor_b32 v42, v66, v202
    v_or3_b32 v40, v40, v41, v42
    v_xor_b32 v41, v67, v202
    v_xor_b32 v42, v68, v202
    v_or3_b32 v40, v40, v41, v42
    v_xor_b32 v41, v69, v202
    v_xor_b32 v42, v70, v202
    v_or3_b32 v40, v40, v41, v42
    v_xor_b32 v41, v71, v202
    v_xor_b32 v42, v72, v202
    v_or3_b32 v40, v40, v41, v42
    v_xor_b32 v41, v73, v202
    v_xor_b32 v42, v74, v202
    v_or3_b32 v40, v40, v41, v42
    v_xor_b32 v41, v75, v202
    v_xor_b32 v42, v76, v202
    v_or3_b32 v40, v40, v41, v42
    v_xor_b32 v41, v77, v202
    v_xor_b32 v42, v78, v202
    v_or3_b32 v40, v40, v41, v42
    v_xor_b32 v41, v79, v202
    v_or_b32 v40, v40, v41
    v_and_b32 v40, 15, v40
    v_cmp_ne_u32 vcc, 0, v40
    s_nop 1
    s_cbranch_vccz L_h2_ok0
    s_add_u32 s17, s16, 36864
    buffer_load_dwordx4 v[64:67], v201, s[8:11], s16 offen sc1
    buffer_load_dwordx4 v[68:71], v199, s[8:11], s16 offen sc1
    buffer_load_dwordx4 v[72:75], v201, s[8:11], s17 offen sc1
    buffer_load_dwordx4 v[76:79], v199, s[8:11], s17 offen sc1
    s_waitcnt vmcnt(4)
    v_xor_b32 v40, v80, v202
    v_xor_b32 v41, v81, v202
    v_xor_b32 v42, v82, v202
    v_or3_b32 v40, v40, v41, v42
    v_xor_b32 v41, v83, v202
    v_xor_b32 v42, v84, v202
    v_or3_b32 v40, v40, v41, v42
    v_xor_b32 v41, v85, v202
    v_xor_b32 v42, v86, v202
    v_or3_b32 v40, v40, v41, v42
    v_xor_b32 v41, v87, v202
    v_xor_b32 v42, v88, v202
    v_or3_b32 v40, v40, v41, v42
    v_xor_b32 v41, v89, v202
    v_xor_b32 v42, v90, v202
    v_or3_b32 v40, v40, v41, v42
    v_xor_b32 v41, v91, v202
    v_xor_b32 v42, v92, v202
    v_or3_b32 v40, v40, v41, v42
    v_xor_b32 v41, v93, v202
    v_xor_b32 v42, v94, v202
    v_or3_b32 v40, v40, v41, v42
    v_xor_b32 v41, v95, v202
    v_or_b32 v40, v40, v41
    v_and_b32 v40, 15, v40
    v_cmp_ne_u32 vcc, 0, v40
    s_nop 1
    s_cbranch_vccz L_h2_ok1
    s_sub_u32 s30, s30, 1
    s_cmp_lg_u32 s30, 0
    s_cbranch_scc1 L_h2
L_h2_ok1:
    v_and_b32 v80, -16, v80
    v_and_b32 v81, -16, v81
    v_and_b32 v82, -16, v82
    v_and_b32 v83, -16, v83
    v_and_b32 v84, -16, v84
    v_and_b32 v85, -16, v85
    v_and_b32 v86, -16, v86
    v_and_b32 v87, -16, v87
    v_and_b32 v88, -16, v88
    v_and_b32 v89, -16, v89
    v_and_b32 v90, -16, v90
    v_and_b32 v91, -16, v91
    v_and_b32 v92, -16, v92
    v_and_b32 v93, -16, v93
    v_and_b32 v94, -16, v94
    v_and_b32 v95, -16, v95
    v_add_f32 v80, v80, v88
    v_add_f32 v81, v81, v89
    v_add_f32 v82, v82, v90
    v_add_f32 v83, v83, v91
    v_add_f32 v84, v84, v92
    v_add_f32 v85, v85, v93
    v_add_f32 v86, v86, v94
    v_add_f32 v87, v87, v95
    v_add_f32 v48, v80, v84
    v_add_f32 v49, v81, v85
    v_add_f32 v50, v82, v86
    v_add_f32 v51, v83, v87
    s_branch L_h2_done
L_h2_ok0:
    v_and_b32 v64, -16, v64
    v_and_b32 v65, -16, v65
    v_and_b32 v66, -16, v66
    v_and_b32 v67, -16, v67
    v_and_b32 v68, -16, v68
    v_and_b32 v69, -16, v69
    v_and_b32 v70, -16, v70
    v_and_b32 v71, -16, v71
    v_and_b32 v72, -16, v72
    v_and_b32 v73, -16, v73
    v_and_b32 v74, -16, v74
    v_and_b32 v75, -16, v75
    v_and_b32 v76, -16, v76
    v_and_b32 v77, -16, v77
    v_and_b32 v78, -16, v78
    v_and_b32 v79, -16, v79
    v_add_f32 v64, v64, v72
    v_add_f32 v65, v65, v73
    v_add_f32 v66, v66, v74
    v_add_f32 v67, v67, v75
    v_add_f32 v68, v68, v76
    v_add_f32 v69, v69, v77
    v_add_f32 v70, v70, v78
    v_add_f32 v71, v71, v79
    v_add_f32 v48, v64, v68
    v_add_f32 v49, v65, v69
    v_add_f32 v50, v66, v70
    v_add_f32 v51, v67, v71
L_h2_done:
    v_add_f32_dpp v48, v48, v48 row_ror:8 row_mask:0xf bank_mask:0xf
    v_add_f32_dpp v49, v49, v49 row_ror:8 row_mask:0xf bank_mask:0xf
    v_add_f32_dpp v50, v50, v50 row_ror:8 row_mask:0xf bank_mask:0xf
    v_add_f32_dpp v51, v51, v51 row_ror:8 row_mask:0xf bank_mask:0xf
    v_permlane16_swap_b32 v48, v49
    s_nop 0
    v_permlane16_swap_b32 v50, v51
    v_add_f32 v48, v48, v49
    v_add_f32 v50, v50, v51
    s_nop 1
    v_permlane32_swap_b32 v48, v50
    v_add_f32 v48, v48, v50
    v_cvt_pk_bf16_f32 v48, v48, v48
    v_and_b32 v48, 0xffff0000, v48
    v_add_f32 v48, v188, v48
    v_cvt_pk_bf16_f32 v48, v48, v48
    v_and_b32 v48, 0xffff0000, v48
    v_add_f32 v48, v48, v192
    v_cvt_pk_bf16_f32 v48, v48, v48
    buffer_store_short v48, v200, s[12:15], s28 offen sc1
    s_cmp_lg_u32 s28, 0
    s_cbranch_scc1 L_noep
    s_mov_b32 s17, 69632
    buffer_store_dword v202, v203, s[8:11], s17 offen sc1
L_noep:
L_end:
    s_endpgm
L_code_end:
.fill 1024, 4, 0xbf810000
.section .rodata,"a"
.p2align 6
.amdhsa_kernel parallel_sum__mha_block_cached__dense_activation_gelu__decode_kernel
  .amdhsa_next_free_vgpr 232
  .amdhsa_next_free_sgpr 96
  .amdhsa_accum_offset 232
  .amdhsa_group_segment_fixed_size 0
  .amdhsa_kernarg_size 104
  .amdhsa_user_sgpr_count 2
  .amdhsa_user_sgpr_kernarg_segment_ptr 1
  .amdhsa_system_sgpr_workgroup_id_x 1
  .amdhsa_float_denorm_mode_32 3
.end_amdhsa_kernel
```
